```python
import torch

def _softmax(x, axis=-1):
    return torch.softmax(x, dim=axis)
def _gelu(x):
    return torch.nn.functional.gelu(x, approximate="tanh")
def _silu(x):
    return torch.nn.functional.silu(x)
def _sigmoid(x):
    return torch.sigmoid(x)
def _layernorm(x, axis=-1, eps=1e-5):
    m = x.mean(dim=axis, keepdim=True)
    v = x.var(dim=axis, keepdim=True, unbiased=False)
    return (x - m) / torch.sqrt(v + eps)
def _scatter_add(tgt, idx, src, axis=0):
    return tgt.clone().index_add_(axis, idx, src)
def _segment_sum(src, seg, n):
    out = torch.zeros((n,) + src.shape[1:], dtype=src.dtype)
    return out.index_add_(0, seg, src)
def _pad(x, pw):
    flat = tuple(v for pair in reversed(pw) for v in pair)
    return torch.nn.functional.pad(x, flat)

kernel_name = 'standalone__gqa_block_cached__near_ridge'

def setup_inputs():

    _w = (lambda a: (lambda t: t.to(torch.bfloat16) if t.is_floating_point() else t)(torch.as_tensor(a)))
    B, Sq, D = 8, 144, 512
    Hq, Hkv, Sk, Dh = 32, 32, 2048, 128
    assert Hq % Hkv == 0, (Hq, Hkv)
    return {
        "x": _w((lambda *s: torch.randn(*s, dtype=torch.bfloat16) * 0.8)(B, Sq, D)),
        "k_cache": _w((lambda *s: torch.randn(*s, dtype=torch.bfloat16) * 0.8)(B, Hkv, Sk, Dh)),
        "v_cache": _w((lambda *s: torch.randn(*s, dtype=torch.bfloat16) * 0.05)(B, Hkv, Sk, Dh)),
        "wq": _w((lambda *s: torch.randn(*s, dtype=torch.bfloat16) * 0.8)(D, Hq * Dh) * (D ** -0.5)),
        "wo": _w((lambda *s: torch.randn(*s, dtype=torch.bfloat16) * 0.05)(Hq * Dh, D) * ((Hq * Dh) ** -0.5)),
    }

def reference(x, k_cache, v_cache, wq, wo):
    B, Sq, D = x.shape
    Hq, Dh = 32, 128
    Hkv = k_cache.shape[1]
    rep = Hq // Hkv
    q = (lambda x, *d: x.permute(*d))((x @ wq).reshape(B, Sq, Hq, Dh), 0, 2, 1, 3)
    k = (lambda x, n, axis: torch.repeat_interleave(x, n, dim=axis))(k_cache, rep, axis=1)
    v = (lambda x, n, axis: torch.repeat_interleave(x, n, dim=axis))(v_cache, rep, axis=1)
    scores = torch.einsum("bhqd,bhkd->bhqk", q, k) * (Dh ** -0.5)
    p = _softmax(scores, axis=-1)
    o = torch.einsum("bhqk,bhkd->bhqd", p, v)
    return (lambda x, *d: x.permute(*d))(o, 0, 2, 1, 3).reshape(B, Sq, Hq * Dh) @ wo
```

```asm
; @launch grid=(256,1,1) block=(256,1,1) lds=163840
.amdgcn_target "amdgcn-amd-amdhsa--gfx950"
.text
.globl standalone__gqa_block_cached__near_ridge_kernel
.p2align 8
.type standalone__gqa_block_cached__near_ridge_kernel,@function
standalone__gqa_block_cached__near_ridge_kernel:
s_cmp_ge_u32 s2, 256
s_cbranch_scc1 L_end
s_load_dwordx8 s[4:11], s[0:1], 0
s_load_dwordx8 s[12:19], s[0:1], 32
v_lshrrev_b32 v1, 6, v0
v_and_b32 v236, 63, v0
v_readfirstlane_b32 s3, v1
s_and_b32 s69, s2, 7
s_lshl_b32 s69, s69, 2
s_lshr_b32 s70, s2, 3
s_and_b32 s70, s70, 3
s_add_u32 s49, s69, s70
s_lshr_b32 s48, s2, 5
s_lshl_b32 s50, s48, 5
s_add_u32 s50, s50, s49
s_and_b32 s55, s2, 63
s_lshl_b32 s55, s55, 13
v_bfe_u32 v239, v236, 2, 2
v_lshlrev_b32 v239, 8, v239
v_lshrrev_b32 v238, 4, v236
v_lshlrev_b32 v240, 6, v238
v_and_b32 v241, 3, v236
v_lshlrev_b32 v241, 4, v241
v_add3_u32 v237, v239, v240, v241
s_waitcnt lgkmcnt(0)
s_lshl_b32 s69, s50, 19
s_lshr_b32 s70, s50, 13
s_add_u32 s28, s6, s69
s_addc_u32 s29, s7, s70
s_mov_b32 s30, 0x80000
s_mov_b32 s31, 0x20000
s_add_u32 s32, s8, s69
s_addc_u32 s33, s9, s70
s_mov_b32 s34, 0x80000
s_mov_b32 s35, 0x20000
s_mov_b32 s56, s55
s_mov_b32 s57, s55
s_cmp_eq_u32 s3, 3
s_cbranch_scc1 L_loader
s_mul_i32 s69, s48, 147456
s_add_u32 s20, s4, s69
s_addc_u32 s21, s5, 0
s_mov_b32 s22, 147456
s_mov_b32 s23, 0x20000
s_mov_b32 s24, s10
s_mov_b32 s25, s11
s_mov_b32 s26, 4194304
s_mov_b32 s27, 0x20000
v_lshlrev_b32 v239, 1, v238
v_mov_b32 v240, 0x78
v_lshrrev_b32 v239, v239, v240
v_and_b32 v239, 3, v239
v_and_b32 v240, 3, v236
v_xor_b32 v240, v240, v239
v_lshlrev_b32 v240, 4, v240
v_lshrrev_b32 v241, 2, v236
v_lshlrev_b32 v241, 10, v241
v_add_u32 v150, v240, v241
v_bfe_u32 v239, v236, 2, 2
v_lshlrev_b32 v239, 13, v239
v_lshlrev_b32 v240, 6, v238
v_and_b32 v241, 3, v236
v_lshlrev_b32 v241, 4, v241
v_add3_u32 v151, v239, v240, v241
v_xor_b32 v154, 16, v241
v_add3_u32 v154, v239, v240, v154
s_mul_i32 s69, s3, 49152
s_add_u32 s59, s69, 0
s_add_u32 s60, s69, 16384
s_add_u32 s61, s69, 32768
s_mul_i32 s68, s3, 3072
s_lshl_b32 s70, s49, 8
s_mul_i32 s69, s3, 3
s_add_u32 s69, s69, 0
s_and_b32 s69, s69, 7
s_mul_i32 s65, s69, 1056
s_lshl_b32 s69, s69, 15
s_add_u32 s62, s69, s70
s_mul_i32 s69, s3, 3
s_add_u32 s69, s69, 1
s_and_b32 s69, s69, 7
s_mul_i32 s66, s69, 1056
s_lshl_b32 s69, s69, 15
s_add_u32 s63, s69, s70
s_mul_i32 s69, s3, 3
s_add_u32 s69, s69, 2
s_and_b32 s69, s69, 7
s_mul_i32 s67, s69, 1056
s_lshl_b32 s69, s69, 15
s_add_u32 s64, s69, s70
s_mul_i32 s69, s3, 3
s_add_u32 s69, s69, 0
s_and_b32 s69, s69, 2
s_cmp_lg_u32 s69, 0
s_cselect_b64 vcc, -1, 0
v_cndmask_b32 v157, v151, v154, vcc
s_mul_i32 s69, s3, 3
s_add_u32 s69, s69, 1
s_and_b32 s69, s69, 2
s_cmp_lg_u32 s69, 0
s_cselect_b64 vcc, -1, 0
v_cndmask_b32 v158, v151, v154, vcc
s_mul_i32 s69, s3, 3
s_add_u32 s69, s69, 2
s_and_b32 s69, s69, 2
s_cmp_lg_u32 s69, 0
s_cselect_b64 vcc, -1, 0
v_cndmask_b32 v159, v151, v154, vcc
s_lshl_b32 s101, s48, 1
s_and_b32 s69, s49, 3
s_lshl_b32 s69, s69, 2
s_add_u32 s101, s101, s69
s_and_b32 s101, s101, 15
s_lshl_b32 s70, s101, 6
s_lshl_b32 s71, s101, 18
s_add_u32 m0, s68, 43776
s_add_u32 s69, s59, s70
buffer_load_dwordx4 v150, s[20:23], s69 offen lds
s_add_u32 m0, s68, 44800
s_add_u32 s69, s60, s70
buffer_load_dwordx4 v150, s[20:23], s69 offen lds
s_add_u32 m0, s68, 45824
s_add_u32 s69, s61, s70
buffer_load_dwordx4 v150, s[20:23], s69 offen lds
s_add_u32 m0, s65, 35328
s_add_u32 s69, s62, s71
buffer_load_dwordx4 v157, s[24:27], s69 offen lds
s_add_u32 m0, s66, 35328
s_add_u32 s69, s63, s71
buffer_load_dwordx4 v158, s[24:27], s69 offen lds
s_add_u32 m0, s67, 35328
s_add_u32 s69, s64, s71
buffer_load_dwordx4 v159, s[24:27], s69 offen lds
s_add_u32 s101, s101, 1
s_and_b32 s101, s101, 15
s_lshl_b32 s70, s101, 6
s_lshl_b32 s71, s101, 18
s_add_u32 m0, s68, 61440
s_add_u32 s69, s59, s70
buffer_load_dwordx4 v150, s[20:23], s69 offen lds
s_add_u32 m0, s68, 62464
s_add_u32 s69, s60, s70
buffer_load_dwordx4 v150, s[20:23], s69 offen lds
s_add_u32 m0, s68, 63488
s_add_u32 s69, s61, s70
buffer_load_dwordx4 v150, s[20:23], s69 offen lds
s_add_u32 m0, s65, 52992
s_add_u32 s69, s62, s71
buffer_load_dwordx4 v157, s[24:27], s69 offen lds
s_add_u32 m0, s66, 52992
s_add_u32 s69, s63, s71
buffer_load_dwordx4 v158, s[24:27], s69 offen lds
s_add_u32 m0, s67, 52992
s_add_u32 s69, s64, s71
buffer_load_dwordx4 v159, s[24:27], s69 offen lds
s_add_u32 s101, s101, 1
s_and_b32 s101, s101, 15
s_lshl_b32 s70, s101, 6
s_lshl_b32 s71, s101, 18
s_add_u32 m0, s68, 79104
s_add_u32 s69, s59, s70
buffer_load_dwordx4 v150, s[20:23], s69 offen lds
s_add_u32 m0, s68, 80128
s_add_u32 s69, s60, s70
buffer_load_dwordx4 v150, s[20:23], s69 offen lds
s_add_u32 m0, s68, 81152
s_add_u32 s69, s61, s70
buffer_load_dwordx4 v150, s[20:23], s69 offen lds
s_add_u32 m0, s65, 70656
s_add_u32 s69, s62, s71
buffer_load_dwordx4 v157, s[24:27], s69 offen lds
s_add_u32 m0, s66, 70656
s_add_u32 s69, s63, s71
buffer_load_dwordx4 v158, s[24:27], s69 offen lds
s_add_u32 m0, s67, 70656
s_add_u32 s69, s64, s71
buffer_load_dwordx4 v159, s[24:27], s69 offen lds
s_add_u32 s101, s101, 1
s_and_b32 s101, s101, 15
s_and_b32 s69, s2, 7
s_lshr_b32 s69, s69, 1
s_lshl_b32 s69, s69, 20
s_lshr_b32 s70, s2, 3
s_lshl_b32 s70, s70, 15
s_add_u32 s69, s69, s70
s_lshl_b32 s70, s3, 13
s_add_u32 s100, s69, s70
s_mov_b32 s40, s12
s_mov_b32 s41, s13
s_mov_b32 s42, 4194304
s_mov_b32 s43, 0x20000
v_lshlrev_b32 v250, 7, v236
v_mul_u32_u24 v239, 2112, v238
v_bfe_u32 v240, v236, 2, 2
v_lshlrev_b32 v240, 6, v240
v_and_b32 v241, 3, v236
v_and_b32 v242, 1, v238
v_xor_b32 v241, v241, v242
v_lshlrev_b32 v241, 4, v241
v_add3_u32 v144, v239, v240, v241
v_and_b32 v242, 1, v236
v_lshlrev_b32 v242, 3, v242
v_sub_u32 v154, v144, v242
v_add_u32 v154, 8, v154
v_add_u32 v144, v144, v242
v_add_u32 v145, 52992, v144
v_add_u32 v146, 105984, v144
v_add_u32 v155, 52992, v154
v_add_u32 v156, 105984, v154
v_bfe_u32 v239, v236, 2, 2
v_lshlrev_b32 v239, 1, v239
v_mov_b32 v240, 0x78
v_lshrrev_b32 v239, v239, v240
v_and_b32 v239, 3, v239
v_xor_b32 v239, v239, v238
v_lshlrev_b32 v239, 4, v239
v_and_b32 v240, 15, v236
v_lshlrev_b32 v240, 6, v240
s_add_u32 s69, s68, 8448
v_add3_u32 v147, v239, v240, s69
v_add_u32 v148, 52992, v147
v_add_u32 v149, 105984, v147
v_bfe_u32 v239, v236, 2, 2
v_mul_u32_u24 v239, 1056, v239
v_and_b32 v240, 3, v236
v_lshlrev_b32 v240, 6, v240
v_lshlrev_b32 v241, 4, v238
v_add3_u32 v234, v239, v240, v241
v_mul_u32_u24 v239, 1056, v238
v_bfe_u32 v240, v236, 2, 2
v_lshlrev_b32 v240, 6, v240
v_and_b32 v241, 3, v236
v_lshlrev_b32 v241, 3, v241
v_add3_u32 v235, v239, v240, v241
v_add_u32 v235, 8448, v235
v_mov_b32 v152, 0x3e0293ee
v_mov_b32 v153, 0x3e0293ee
v_mov_b32 v228, 0x3f803f80
v_mov_b32 v229, 0x3f803f80
v_mov_b32 v230, 0x3f803f80
v_mov_b32 v231, 0x3f803f80
s_waitcnt vmcnt(12)
s_barrier
ds_read_b128 a[128:131], v147 offset:35328
ds_read_b128 a[132:135], v147 offset:36352
ds_read_b128 a[136:139], v147 offset:37376
ds_read_b64_tr_b16 a[64:65], v144 offset:35328
ds_read_b64_tr_b16 a[66:67], v144 offset:36384
ds_read_b64_tr_b16 a[68:69], v154 offset:35328
ds_read_b64_tr_b16 a[70:71], v154 offset:36384
ds_read_b64_tr_b16 a[72:73], v144 offset:35584
ds_read_b64_tr_b16 a[74:75], v144 offset:36640
ds_read_b64_tr_b16 a[76:77], v154 offset:35584
ds_read_b64_tr_b16 a[78:79], v154 offset:36640
ds_read_b64_tr_b16 a[80:81], v144 offset:35840
ds_read_b64_tr_b16 a[82:83], v144 offset:36896
ds_read_b64_tr_b16 a[84:85], v154 offset:35840
ds_read_b64_tr_b16 a[86:87], v154 offset:36896
ds_read_b64_tr_b16 a[88:89], v144 offset:36096
ds_read_b64_tr_b16 a[90:91], v144 offset:37152
ds_read_b64_tr_b16 a[92:93], v154 offset:36096
ds_read_b64_tr_b16 a[94:95], v154 offset:37152
s_waitcnt vmcnt(6) lgkmcnt(0)
s_barrier
v_mfma_f32_16x16x32_bf16 v[0:3], a[64:67], a[128:131], 0
ds_read_b128 a[140:143], v148 offset:0
ds_read_b128 a[144:147], v148 offset:1024
v_mfma_f32_16x16x32_bf16 v[32:35], a[64:67], a[132:135], 0
ds_read_b128 a[148:151], v148 offset:2048
ds_read_b64_tr_b16 a[96:97], v145 offset:0
v_mfma_f32_16x16x32_bf16 v[64:67], a[64:67], a[136:139], 0
ds_read_b64_tr_b16 a[98:99], v145 offset:1056
ds_read_b64_tr_b16 a[100:101], v155 offset:0
v_mfma_f32_16x16x32_bf16 v[4:7], a[68:71], a[128:131], 0
ds_read_b64_tr_b16 a[102:103], v155 offset:1056
ds_read_b64_tr_b16 a[104:105], v145 offset:256
v_mfma_f32_16x16x32_bf16 v[36:39], a[68:71], a[132:135], 0
ds_read_b64_tr_b16 a[106:107], v145 offset:1312
ds_read_b64_tr_b16 a[108:109], v155 offset:256
v_mfma_f32_16x16x32_bf16 v[68:71], a[68:71], a[136:139], 0
ds_read_b64_tr_b16 a[110:111], v155 offset:1312
ds_read_b64_tr_b16 a[112:113], v145 offset:512
v_mfma_f32_16x16x32_bf16 v[8:11], a[72:75], a[128:131], 0
ds_read_b64_tr_b16 a[114:115], v145 offset:1568
ds_read_b64_tr_b16 a[116:117], v155 offset:512
v_mfma_f32_16x16x32_bf16 v[40:43], a[72:75], a[132:135], 0
ds_read_b64_tr_b16 a[118:119], v155 offset:1568
ds_read_b64_tr_b16 a[120:121], v145 offset:768
v_mfma_f32_16x16x32_bf16 v[72:75], a[72:75], a[136:139], 0
ds_read_b64_tr_b16 a[122:123], v145 offset:1824
ds_read_b64_tr_b16 a[124:125], v155 offset:768
v_mfma_f32_16x16x32_bf16 v[12:15], a[76:79], a[128:131], 0
ds_read_b64_tr_b16 a[126:127], v155 offset:1824
v_mfma_f32_16x16x32_bf16 v[44:47], a[76:79], a[132:135], 0
s_lshl_b32 s70, s101, 6
s_lshl_b32 s71, s101, 18
s_add_u32 m0, s68, 96768
s_add_u32 s69, s59, s70
v_mfma_f32_16x16x32_bf16 v[76:79], a[76:79], a[136:139], 0
buffer_load_dwordx4 v150, s[20:23], s69 offen lds
s_add_u32 m0, s68, 97792
s_add_u32 s69, s60, s70
buffer_load_dwordx4 v150, s[20:23], s69 offen lds
v_mfma_f32_16x16x32_bf16 v[16:19], a[80:83], a[128:131], 0
s_add_u32 m0, s68, 98816
s_add_u32 s69, s61, s70
buffer_load_dwordx4 v150, s[20:23], s69 offen lds
s_add_u32 m0, s65, 88320
v_mfma_f32_16x16x32_bf16 v[48:51], a[80:83], a[132:135], 0
s_add_u32 s69, s62, s71
buffer_load_dwordx4 v157, s[24:27], s69 offen lds
s_add_u32 m0, s66, 88320
s_add_u32 s69, s63, s71
v_mfma_f32_16x16x32_bf16 v[80:83], a[80:83], a[136:139], 0
buffer_load_dwordx4 v158, s[24:27], s69 offen lds
s_add_u32 m0, s67, 88320
s_add_u32 s69, s64, s71
buffer_load_dwordx4 v159, s[24:27], s69 offen lds
v_mfma_f32_16x16x32_bf16 v[20:23], a[84:87], a[128:131], 0
s_add_u32 s101, s101, 1
s_and_b32 s101, s101, 15
s_lshl_b32 s70, s101, 6
s_lshl_b32 s71, s101, 18
v_mfma_f32_16x16x32_bf16 v[52:55], a[84:87], a[132:135], 0
s_add_u32 m0, s68, 114432
s_add_u32 s69, s59, s70
buffer_load_dwordx4 v150, s[20:23], s69 offen lds
s_add_u32 m0, s68, 115456
v_mfma_f32_16x16x32_bf16 v[84:87], a[84:87], a[136:139], 0
s_add_u32 s69, s60, s70
buffer_load_dwordx4 v150, s[20:23], s69 offen lds
s_add_u32 m0, s68, 116480
s_add_u32 s69, s61, s70
v_mfma_f32_16x16x32_bf16 v[24:27], a[88:91], a[128:131], 0
buffer_load_dwordx4 v150, s[20:23], s69 offen lds
s_add_u32 m0, s65, 105984
s_add_u32 s69, s62, s71
buffer_load_dwordx4 v157, s[24:27], s69 offen lds
v_mfma_f32_16x16x32_bf16 v[56:59], a[88:91], a[132:135], 0
s_add_u32 m0, s66, 105984
s_add_u32 s69, s63, s71
buffer_load_dwordx4 v158, s[24:27], s69 offen lds
s_add_u32 m0, s67, 105984
v_mfma_f32_16x16x32_bf16 v[88:91], a[88:91], a[136:139], 0
s_add_u32 s69, s64, s71
buffer_load_dwordx4 v159, s[24:27], s69 offen lds
s_add_u32 s101, s101, 1
s_and_b32 s101, s101, 15
v_mfma_f32_16x16x32_bf16 v[28:31], a[92:95], a[128:131], 0
v_mfma_f32_16x16x32_bf16 v[60:63], a[92:95], a[132:135], 0
v_mfma_f32_16x16x32_bf16 v[92:95], a[92:95], a[136:139], 0
s_waitcnt vmcnt(12) lgkmcnt(0)
s_barrier
v_mfma_f32_16x16x32_bf16 v[0:3], a[96:99], a[140:143], v[0:3]
ds_read_b128 a[128:131], v148 offset:17664
ds_read_b128 a[132:135], v148 offset:18688
v_mfma_f32_16x16x32_bf16 v[32:35], a[96:99], a[144:147], v[32:35]
ds_read_b128 a[136:139], v148 offset:19712
ds_read_b64_tr_b16 a[64:65], v145 offset:17664
v_mfma_f32_16x16x32_bf16 v[64:67], a[96:99], a[148:151], v[64:67]
ds_read_b64_tr_b16 a[66:67], v145 offset:18720
ds_read_b64_tr_b16 a[68:69], v155 offset:17664
v_mfma_f32_16x16x32_bf16 v[4:7], a[100:103], a[140:143], v[4:7]
ds_read_b64_tr_b16 a[70:71], v155 offset:18720
ds_read_b64_tr_b16 a[72:73], v145 offset:17920
v_mfma_f32_16x16x32_bf16 v[36:39], a[100:103], a[144:147], v[36:39]
ds_read_b64_tr_b16 a[74:75], v145 offset:18976
ds_read_b64_tr_b16 a[76:77], v155 offset:17920
v_mfma_f32_16x16x32_bf16 v[68:71], a[100:103], a[148:151], v[68:71]
ds_read_b64_tr_b16 a[78:79], v155 offset:18976
ds_read_b64_tr_b16 a[80:81], v145 offset:18176
v_mfma_f32_16x16x32_bf16 v[8:11], a[104:107], a[140:143], v[8:11]
ds_read_b64_tr_b16 a[82:83], v145 offset:19232
ds_read_b64_tr_b16 a[84:85], v155 offset:18176
v_mfma_f32_16x16x32_bf16 v[40:43], a[104:107], a[144:147], v[40:43]
ds_read_b64_tr_b16 a[86:87], v155 offset:19232
ds_read_b64_tr_b16 a[88:89], v145 offset:18432
v_mfma_f32_16x16x32_bf16 v[72:75], a[104:107], a[148:151], v[72:75]
ds_read_b64_tr_b16 a[90:91], v145 offset:19488
ds_read_b64_tr_b16 a[92:93], v155 offset:18432
v_mfma_f32_16x16x32_bf16 v[12:15], a[108:111], a[140:143], v[12:15]
ds_read_b64_tr_b16 a[94:95], v155 offset:19488
v_mfma_f32_16x16x32_bf16 v[44:47], a[108:111], a[144:147], v[44:47]
s_lshl_b32 s70, s101, 6
s_lshl_b32 s71, s101, 18
s_add_u32 m0, s68, 132096
s_add_u32 s69, s59, s70
v_mfma_f32_16x16x32_bf16 v[76:79], a[108:111], a[148:151], v[76:79]
buffer_load_dwordx4 v150, s[20:23], s69 offen lds
s_add_u32 m0, s68, 133120
s_add_u32 s69, s60, s70
buffer_load_dwordx4 v150, s[20:23], s69 offen lds
v_mfma_f32_16x16x32_bf16 v[16:19], a[112:115], a[140:143], v[16:19]
s_add_u32 m0, s68, 134144
s_add_u32 s69, s61, s70
buffer_load_dwordx4 v150, s[20:23], s69 offen lds
s_add_u32 m0, s65, 123648
v_mfma_f32_16x16x32_bf16 v[48:51], a[112:115], a[144:147], v[48:51]
s_add_u32 s69, s62, s71
buffer_load_dwordx4 v157, s[24:27], s69 offen lds
s_add_u32 m0, s66, 123648
s_add_u32 s69, s63, s71
v_mfma_f32_16x16x32_bf16 v[80:83], a[112:115], a[148:151], v[80:83]
buffer_load_dwordx4 v158, s[24:27], s69 offen lds
s_add_u32 m0, s67, 123648
s_add_u32 s69, s64, s71
buffer_load_dwordx4 v159, s[24:27], s69 offen lds
v_mfma_f32_16x16x32_bf16 v[20:23], a[116:119], a[140:143], v[20:23]
s_add_u32 s101, s101, 1
s_and_b32 s101, s101, 15
s_lshl_b32 s70, s101, 6
s_lshl_b32 s71, s101, 18
v_mfma_f32_16x16x32_bf16 v[52:55], a[116:119], a[144:147], v[52:55]
s_add_u32 m0, s68, 149760
s_add_u32 s69, s59, s70
buffer_load_dwordx4 v150, s[20:23], s69 offen lds
s_add_u32 m0, s68, 150784
v_mfma_f32_16x16x32_bf16 v[84:87], a[116:119], a[148:151], v[84:87]
s_add_u32 s69, s60, s70
buffer_load_dwordx4 v150, s[20:23], s69 offen lds
s_add_u32 m0, s68, 151808
s_add_u32 s69, s61, s70
v_mfma_f32_16x16x32_bf16 v[24:27], a[120:123], a[140:143], v[24:27]
buffer_load_dwordx4 v150, s[20:23], s69 offen lds
s_add_u32 m0, s65, 141312
s_add_u32 s69, s62, s71
buffer_load_dwordx4 v157, s[24:27], s69 offen lds
v_mfma_f32_16x16x32_bf16 v[56:59], a[120:123], a[144:147], v[56:59]
s_add_u32 m0, s66, 141312
s_add_u32 s69, s63, s71
buffer_load_dwordx4 v158, s[24:27], s69 offen lds
s_add_u32 m0, s67, 141312
v_mfma_f32_16x16x32_bf16 v[88:91], a[120:123], a[148:151], v[88:91]
s_add_u32 s69, s64, s71
buffer_load_dwordx4 v159, s[24:27], s69 offen lds
s_add_u32 s101, s101, 1
s_and_b32 s101, s101, 15
v_mfma_f32_16x16x32_bf16 v[28:31], a[124:127], a[140:143], v[28:31]
v_mfma_f32_16x16x32_bf16 v[60:63], a[124:127], a[144:147], v[60:63]
v_mfma_f32_16x16x32_bf16 v[92:95], a[124:127], a[148:151], v[92:95]
s_waitcnt vmcnt(18) lgkmcnt(0)
s_barrier
v_mfma_f32_16x16x32_bf16 v[0:3], a[64:67], a[128:131], v[0:3]
ds_read_b128 a[140:143], v148 offset:35328
ds_read_b128 a[144:147], v148 offset:36352
v_mfma_f32_16x16x32_bf16 v[32:35], a[64:67], a[132:135], v[32:35]
ds_read_b128 a[148:151], v148 offset:37376
ds_read_b64_tr_b16 a[96:97], v145 offset:35328
v_mfma_f32_16x16x32_bf16 v[64:67], a[64:67], a[136:139], v[64:67]
ds_read_b64_tr_b16 a[98:99], v145 offset:36384
ds_read_b64_tr_b16 a[100:101], v155 offset:35328
v_mfma_f32_16x16x32_bf16 v[4:7], a[68:71], a[128:131], v[4:7]
ds_read_b64_tr_b16 a[102:103], v155 offset:36384
ds_read_b64_tr_b16 a[104:105], v145 offset:35584
v_mfma_f32_16x16x32_bf16 v[36:39], a[68:71], a[132:135], v[36:39]
ds_read_b64_tr_b16 a[106:107], v145 offset:36640
ds_read_b64_tr_b16 a[108:109], v155 offset:35584
v_mfma_f32_16x16x32_bf16 v[68:71], a[68:71], a[136:139], v[68:71]
ds_read_b64_tr_b16 a[110:111], v155 offset:36640
ds_read_b64_tr_b16 a[112:113], v145 offset:35840
v_mfma_f32_16x16x32_bf16 v[8:11], a[72:75], a[128:131], v[8:11]
ds_read_b64_tr_b16 a[114:115], v145 offset:36896
ds_read_b64_tr_b16 a[116:117], v155 offset:35840
v_mfma_f32_16x16x32_bf16 v[40:43], a[72:75], a[132:135], v[40:43]
ds_read_b64_tr_b16 a[118:119], v155 offset:36896
ds_read_b64_tr_b16 a[120:121], v145 offset:36096
v_mfma_f32_16x16x32_bf16 v[72:75], a[72:75], a[136:139], v[72:75]
ds_read_b64_tr_b16 a[122:123], v145 offset:37152
ds_read_b64_tr_b16 a[124:125], v155 offset:36096
v_mfma_f32_16x16x32_bf16 v[12:15], a[76:79], a[128:131], v[12:15]
ds_read_b64_tr_b16 a[126:127], v155 offset:37152
v_mfma_f32_16x16x32_bf16 v[44:47], a[76:79], a[132:135], v[44:47]
s_lshl_b32 s70, s101, 6
s_lshl_b32 s71, s101, 18
s_add_u32 m0, s68, 8448
s_add_u32 s69, s59, s70
v_mfma_f32_16x16x32_bf16 v[76:79], a[76:79], a[136:139], v[76:79]
buffer_load_dwordx4 v150, s[20:23], s69 offen lds
s_add_u32 m0, s68, 9472
s_add_u32 s69, s60, s70
buffer_load_dwordx4 v150, s[20:23], s69 offen lds
v_mfma_f32_16x16x32_bf16 v[16:19], a[80:83], a[128:131], v[16:19]
s_add_u32 m0, s68, 10496
s_add_u32 s69, s61, s70
buffer_load_dwordx4 v150, s[20:23], s69 offen lds
s_add_u32 m0, s65, 0
v_mfma_f32_16x16x32_bf16 v[48:51], a[80:83], a[132:135], v[48:51]
s_add_u32 s69, s62, s71
buffer_load_dwordx4 v157, s[24:27], s69 offen lds
s_add_u32 m0, s66, 0
s_add_u32 s69, s63, s71
v_mfma_f32_16x16x32_bf16 v[80:83], a[80:83], a[136:139], v[80:83]
buffer_load_dwordx4 v158, s[24:27], s69 offen lds
s_add_u32 m0, s67, 0
s_add_u32 s69, s64, s71
buffer_load_dwordx4 v159, s[24:27], s69 offen lds
v_mfma_f32_16x16x32_bf16 v[20:23], a[84:87], a[128:131], v[20:23]
s_add_u32 s101, s101, 1
s_and_b32 s101, s101, 15
s_lshl_b32 s70, s101, 6
s_lshl_b32 s71, s101, 18
v_mfma_f32_16x16x32_bf16 v[52:55], a[84:87], a[132:135], v[52:55]
s_add_u32 m0, s68, 26112
s_add_u32 s69, s59, s70
buffer_load_dwordx4 v150, s[20:23], s69 offen lds
s_add_u32 m0, s68, 27136
v_mfma_f32_16x16x32_bf16 v[84:87], a[84:87], a[136:139], v[84:87]
s_add_u32 s69, s60, s70
buffer_load_dwordx4 v150, s[20:23], s69 offen lds
s_add_u32 m0, s68, 28160
s_add_u32 s69, s61, s70
v_mfma_f32_16x16x32_bf16 v[24:27], a[88:91], a[128:131], v[24:27]
buffer_load_dwordx4 v150, s[20:23], s69 offen lds
s_add_u32 m0, s65, 17664
s_add_u32 s69, s62, s71
buffer_load_dwordx4 v157, s[24:27], s69 offen lds
v_mfma_f32_16x16x32_bf16 v[56:59], a[88:91], a[132:135], v[56:59]
s_add_u32 m0, s66, 17664
s_add_u32 s69, s63, s71
buffer_load_dwordx4 v158, s[24:27], s69 offen lds
s_add_u32 m0, s67, 17664
v_mfma_f32_16x16x32_bf16 v[88:91], a[88:91], a[136:139], v[88:91]
s_add_u32 s69, s64, s71
buffer_load_dwordx4 v159, s[24:27], s69 offen lds
s_add_u32 s101, s101, 1
s_and_b32 s101, s101, 15
v_mfma_f32_16x16x32_bf16 v[28:31], a[92:95], a[128:131], v[28:31]
v_mfma_f32_16x16x32_bf16 v[60:63], a[92:95], a[132:135], v[60:63]
v_mfma_f32_16x16x32_bf16 v[92:95], a[92:95], a[136:139], v[92:95]
s_waitcnt vmcnt(24) lgkmcnt(0)
s_barrier
v_mfma_f32_16x16x32_bf16 v[0:3], a[96:99], a[140:143], v[0:3]
ds_read_b128 a[128:131], v149 offset:0
ds_read_b128 a[132:135], v149 offset:1024
v_mfma_f32_16x16x32_bf16 v[32:35], a[96:99], a[144:147], v[32:35]
ds_read_b128 a[136:139], v149 offset:2048
ds_read_b64_tr_b16 a[64:65], v146 offset:0
v_mfma_f32_16x16x32_bf16 v[64:67], a[96:99], a[148:151], v[64:67]
ds_read_b64_tr_b16 a[66:67], v146 offset:1056
ds_read_b64_tr_b16 a[68:69], v156 offset:0
v_mfma_f32_16x16x32_bf16 v[4:7], a[100:103], a[140:143], v[4:7]
ds_read_b64_tr_b16 a[70:71], v156 offset:1056
ds_read_b64_tr_b16 a[72:73], v146 offset:256
v_mfma_f32_16x16x32_bf16 v[36:39], a[100:103], a[144:147], v[36:39]
ds_read_b64_tr_b16 a[74:75], v146 offset:1312
ds_read_b64_tr_b16 a[76:77], v156 offset:256
v_mfma_f32_16x16x32_bf16 v[68:71], a[100:103], a[148:151], v[68:71]
ds_read_b64_tr_b16 a[78:79], v156 offset:1312
ds_read_b64_tr_b16 a[80:81], v146 offset:512
v_mfma_f32_16x16x32_bf16 v[8:11], a[104:107], a[140:143], v[8:11]
ds_read_b64_tr_b16 a[82:83], v146 offset:1568
ds_read_b64_tr_b16 a[84:85], v156 offset:512
v_mfma_f32_16x16x32_bf16 v[40:43], a[104:107], a[144:147], v[40:43]
ds_read_b64_tr_b16 a[86:87], v156 offset:1568
ds_read_b64_tr_b16 a[88:89], v146 offset:768
v_mfma_f32_16x16x32_bf16 v[72:75], a[104:107], a[148:151], v[72:75]
ds_read_b64_tr_b16 a[90:91], v146 offset:1824
ds_read_b64_tr_b16 a[92:93], v156 offset:768
v_mfma_f32_16x16x32_bf16 v[12:15], a[108:111], a[140:143], v[12:15]
ds_read_b64_tr_b16 a[94:95], v156 offset:1824
v_mfma_f32_16x16x32_bf16 v[44:47], a[108:111], a[144:147], v[44:47]
s_lshl_b32 s70, s101, 6
s_lshl_b32 s71, s101, 18
s_add_u32 m0, s68, 43776
s_add_u32 s69, s59, s70
v_mfma_f32_16x16x32_bf16 v[76:79], a[108:111], a[148:151], v[76:79]
buffer_load_dwordx4 v150, s[20:23], s69 offen lds
s_add_u32 m0, s68, 44800
s_add_u32 s69, s60, s70
buffer_load_dwordx4 v150, s[20:23], s69 offen lds
v_mfma_f32_16x16x32_bf16 v[16:19], a[112:115], a[140:143], v[16:19]
s_add_u32 m0, s68, 45824
s_add_u32 s69, s61, s70
buffer_load_dwordx4 v150, s[20:23], s69 offen lds
s_add_u32 m0, s65, 35328
v_mfma_f32_16x16x32_bf16 v[48:51], a[112:115], a[144:147], v[48:51]
s_add_u32 s69, s62, s71
buffer_load_dwordx4 v157, s[24:27], s69 offen lds
s_add_u32 m0, s66, 35328
s_add_u32 s69, s63, s71
v_mfma_f32_16x16x32_bf16 v[80:83], a[112:115], a[148:151], v[80:83]
buffer_load_dwordx4 v158, s[24:27], s69 offen lds
s_add_u32 m0, s67, 35328
s_add_u32 s69, s64, s71
buffer_load_dwordx4 v159, s[24:27], s69 offen lds
v_mfma_f32_16x16x32_bf16 v[20:23], a[116:119], a[140:143], v[20:23]
s_add_u32 s101, s101, 1
s_and_b32 s101, s101, 15
s_lshl_b32 s70, s101, 6
s_lshl_b32 s71, s101, 18
v_mfma_f32_16x16x32_bf16 v[52:55], a[116:119], a[144:147], v[52:55]
s_add_u32 m0, s68, 61440
s_add_u32 s69, s59, s70
buffer_load_dwordx4 v150, s[20:23], s69 offen lds
s_add_u32 m0, s68, 62464
v_mfma_f32_16x16x32_bf16 v[84:87], a[116:119], a[148:151], v[84:87]
s_add_u32 s69, s60, s70
buffer_load_dwordx4 v150, s[20:23], s69 offen lds
s_add_u32 m0, s68, 63488
s_add_u32 s69, s61, s70
v_mfma_f32_16x16x32_bf16 v[24:27], a[120:123], a[140:143], v[24:27]
buffer_load_dwordx4 v150, s[20:23], s69 offen lds
s_add_u32 m0, s65, 52992
s_add_u32 s69, s62, s71
buffer_load_dwordx4 v157, s[24:27], s69 offen lds
v_mfma_f32_16x16x32_bf16 v[56:59], a[120:123], a[144:147], v[56:59]
s_add_u32 m0, s66, 52992
s_add_u32 s69, s63, s71
buffer_load_dwordx4 v158, s[24:27], s69 offen lds
s_add_u32 m0, s67, 52992
v_mfma_f32_16x16x32_bf16 v[88:91], a[120:123], a[148:151], v[88:91]
s_add_u32 s69, s64, s71
buffer_load_dwordx4 v159, s[24:27], s69 offen lds
s_add_u32 s101, s101, 1
s_and_b32 s101, s101, 15
v_mfma_f32_16x16x32_bf16 v[28:31], a[124:127], a[140:143], v[28:31]
v_mfma_f32_16x16x32_bf16 v[60:63], a[124:127], a[144:147], v[60:63]
v_mfma_f32_16x16x32_bf16 v[92:95], a[124:127], a[148:151], v[92:95]
s_waitcnt vmcnt(30) lgkmcnt(0)
s_barrier
v_mfma_f32_16x16x32_bf16 v[0:3], a[64:67], a[128:131], v[0:3]
ds_read_b128 a[140:143], v149 offset:17664
ds_read_b128 a[144:147], v149 offset:18688
v_mfma_f32_16x16x32_bf16 v[32:35], a[64:67], a[132:135], v[32:35]
ds_read_b128 a[148:151], v149 offset:19712
ds_read_b64_tr_b16 a[96:97], v146 offset:17664
v_mfma_f32_16x16x32_bf16 v[64:67], a[64:67], a[136:139], v[64:67]
ds_read_b64_tr_b16 a[98:99], v146 offset:18720
ds_read_b64_tr_b16 a[100:101], v156 offset:17664
v_mfma_f32_16x16x32_bf16 v[4:7], a[68:71], a[128:131], v[4:7]
ds_read_b64_tr_b16 a[102:103], v156 offset:18720
ds_read_b64_tr_b16 a[104:105], v146 offset:17920
v_mfma_f32_16x16x32_bf16 v[36:39], a[68:71], a[132:135], v[36:39]
ds_read_b64_tr_b16 a[106:107], v146 offset:18976
ds_read_b64_tr_b16 a[108:109], v156 offset:17920
v_mfma_f32_16x16x32_bf16 v[68:71], a[68:71], a[136:139], v[68:71]
ds_read_b64_tr_b16 a[110:111], v156 offset:18976
ds_read_b64_tr_b16 a[112:113], v146 offset:18176
v_mfma_f32_16x16x32_bf16 v[8:11], a[72:75], a[128:131], v[8:11]
ds_read_b64_tr_b16 a[114:115], v146 offset:19232
ds_read_b64_tr_b16 a[116:117], v156 offset:18176
v_mfma_f32_16x16x32_bf16 v[40:43], a[72:75], a[132:135], v[40:43]
ds_read_b64_tr_b16 a[118:119], v156 offset:19232
ds_read_b64_tr_b16 a[120:121], v146 offset:18432
v_mfma_f32_16x16x32_bf16 v[72:75], a[72:75], a[136:139], v[72:75]
ds_read_b64_tr_b16 a[122:123], v146 offset:19488
ds_read_b64_tr_b16 a[124:125], v156 offset:18432
v_mfma_f32_16x16x32_bf16 v[12:15], a[76:79], a[128:131], v[12:15]
ds_read_b64_tr_b16 a[126:127], v156 offset:19488
v_mfma_f32_16x16x32_bf16 v[44:47], a[76:79], a[132:135], v[44:47]
s_lshl_b32 s70, s101, 6
s_lshl_b32 s71, s101, 18
s_add_u32 m0, s68, 79104
s_add_u32 s69, s59, s70
v_mfma_f32_16x16x32_bf16 v[76:79], a[76:79], a[136:139], v[76:79]
buffer_load_dwordx4 v150, s[20:23], s69 offen lds
s_add_u32 m0, s68, 80128
s_add_u32 s69, s60, s70
buffer_load_dwordx4 v150, s[20:23], s69 offen lds
v_mfma_f32_16x16x32_bf16 v[16:19], a[80:83], a[128:131], v[16:19]
s_add_u32 m0, s68, 81152
s_add_u32 s69, s61, s70
buffer_load_dwordx4 v150, s[20:23], s69 offen lds
s_add_u32 m0, s65, 70656
v_mfma_f32_16x16x32_bf16 v[48:51], a[80:83], a[132:135], v[48:51]
s_add_u32 s69, s62, s71
buffer_load_dwordx4 v157, s[24:27], s69 offen lds
s_add_u32 m0, s66, 70656
s_add_u32 s69, s63, s71
v_mfma_f32_16x16x32_bf16 v[80:83], a[80:83], a[136:139], v[80:83]
buffer_load_dwordx4 v158, s[24:27], s69 offen lds
s_add_u32 m0, s67, 70656
s_add_u32 s69, s64, s71
buffer_load_dwordx4 v159, s[24:27], s69 offen lds
v_mfma_f32_16x16x32_bf16 v[20:23], a[84:87], a[128:131], v[20:23]
s_add_u32 s101, s101, 1
s_and_b32 s101, s101, 15
s_lshl_b32 s70, s101, 6
s_lshl_b32 s71, s101, 18
v_mfma_f32_16x16x32_bf16 v[52:55], a[84:87], a[132:135], v[52:55]
s_add_u32 m0, s68, 96768
s_add_u32 s69, s59, s70
buffer_load_dwordx4 v150, s[20:23], s69 offen lds
s_add_u32 m0, s68, 97792
v_mfma_f32_16x16x32_bf16 v[84:87], a[84:87], a[136:139], v[84:87]
s_add_u32 s69, s60, s70
buffer_load_dwordx4 v150, s[20:23], s69 offen lds
s_add_u32 m0, s68, 98816
s_add_u32 s69, s61, s70
v_mfma_f32_16x16x32_bf16 v[24:27], a[88:91], a[128:131], v[24:27]
buffer_load_dwordx4 v150, s[20:23], s69 offen lds
s_add_u32 m0, s65, 88320
s_add_u32 s69, s62, s71
buffer_load_dwordx4 v157, s[24:27], s69 offen lds
v_mfma_f32_16x16x32_bf16 v[56:59], a[88:91], a[132:135], v[56:59]
s_add_u32 m0, s66, 88320
s_add_u32 s69, s63, s71
buffer_load_dwordx4 v158, s[24:27], s69 offen lds
s_add_u32 m0, s67, 88320
v_mfma_f32_16x16x32_bf16 v[88:91], a[88:91], a[136:139], v[88:91]
s_add_u32 s69, s64, s71
buffer_load_dwordx4 v159, s[24:27], s69 offen lds
s_add_u32 s101, s101, 1
s_and_b32 s101, s101, 15
v_mfma_f32_16x16x32_bf16 v[28:31], a[92:95], a[128:131], v[28:31]
v_mfma_f32_16x16x32_bf16 v[60:63], a[92:95], a[132:135], v[60:63]
v_mfma_f32_16x16x32_bf16 v[92:95], a[92:95], a[136:139], v[92:95]
s_waitcnt vmcnt(36) lgkmcnt(0)
s_barrier
v_mfma_f32_16x16x32_bf16 v[0:3], a[96:99], a[140:143], v[0:3]
ds_read_b128 a[128:131], v149 offset:35328
ds_read_b128 a[132:135], v149 offset:36352
v_mfma_f32_16x16x32_bf16 v[32:35], a[96:99], a[144:147], v[32:35]
ds_read_b128 a[136:139], v149 offset:37376
ds_read_b64_tr_b16 a[64:65], v146 offset:35328
v_mfma_f32_16x16x32_bf16 v[64:67], a[96:99], a[148:151], v[64:67]
ds_read_b64_tr_b16 a[66:67], v146 offset:36384
ds_read_b64_tr_b16 a[68:69], v156 offset:35328
v_mfma_f32_16x16x32_bf16 v[4:7], a[100:103], a[140:143], v[4:7]
ds_read_b64_tr_b16 a[70:71], v156 offset:36384
ds_read_b64_tr_b16 a[72:73], v146 offset:35584
v_mfma_f32_16x16x32_bf16 v[36:39], a[100:103], a[144:147], v[36:39]
ds_read_b64_tr_b16 a[74:75], v146 offset:36640
ds_read_b64_tr_b16 a[76:77], v156 offset:35584
v_mfma_f32_16x16x32_bf16 v[68:71], a[100:103], a[148:151], v[68:71]
ds_read_b64_tr_b16 a[78:79], v156 offset:36640
ds_read_b64_tr_b16 a[80:81], v146 offset:35840
v_mfma_f32_16x16x32_bf16 v[8:11], a[104:107], a[140:143], v[8:11]
ds_read_b64_tr_b16 a[82:83], v146 offset:36896
ds_read_b64_tr_b16 a[84:85], v156 offset:35840
v_mfma_f32_16x16x32_bf16 v[40:43], a[104:107], a[144:147], v[40:43]
ds_read_b64_tr_b16 a[86:87], v156 offset:36896
ds_read_b64_tr_b16 a[88:89], v146 offset:36096
v_mfma_f32_16x16x32_bf16 v[72:75], a[104:107], a[148:151], v[72:75]
ds_read_b64_tr_b16 a[90:91], v146 offset:37152
ds_read_b64_tr_b16 a[92:93], v156 offset:36096
v_mfma_f32_16x16x32_bf16 v[12:15], a[108:111], a[140:143], v[12:15]
ds_read_b64_tr_b16 a[94:95], v156 offset:37152
v_mfma_f32_16x16x32_bf16 v[44:47], a[108:111], a[144:147], v[44:47]
s_lshl_b32 s70, s101, 6
s_lshl_b32 s71, s101, 18
s_add_u32 m0, s68, 114432
s_add_u32 s69, s59, s70
v_mfma_f32_16x16x32_bf16 v[76:79], a[108:111], a[148:151], v[76:79]
buffer_load_dwordx4 v150, s[20:23], s69 offen lds
s_add_u32 m0, s68, 115456
s_add_u32 s69, s60, s70
buffer_load_dwordx4 v150, s[20:23], s69 offen lds
v_mfma_f32_16x16x32_bf16 v[16:19], a[112:115], a[140:143], v[16:19]
s_add_u32 m0, s68, 116480
s_add_u32 s69, s61, s70
buffer_load_dwordx4 v150, s[20:23], s69 offen lds
s_add_u32 m0, s65, 105984
v_mfma_f32_16x16x32_bf16 v[48:51], a[112:115], a[144:147], v[48:51]
s_add_u32 s69, s62, s71
buffer_load_dwordx4 v157, s[24:27], s69 offen lds
s_add_u32 m0, s66, 105984
s_add_u32 s69, s63, s71
v_mfma_f32_16x16x32_bf16 v[80:83], a[112:115], a[148:151], v[80:83]
buffer_load_dwordx4 v158, s[24:27], s69 offen lds
s_add_u32 m0, s67, 105984
s_add_u32 s69, s64, s71
buffer_load_dwordx4 v159, s[24:27], s69 offen lds
v_mfma_f32_16x16x32_bf16 v[20:23], a[116:119], a[140:143], v[20:23]
s_add_u32 s101, s101, 1
s_and_b32 s101, s101, 15
s_lshl_b32 s70, s101, 6
s_lshl_b32 s71, s101, 18
v_mfma_f32_16x16x32_bf16 v[52:55], a[116:119], a[144:147], v[52:55]
s_add_u32 m0, s68, 132096
s_add_u32 s69, s59, s70
buffer_load_dwordx4 v150, s[20:23], s69 offen lds
s_add_u32 m0, s68, 133120
v_mfma_f32_16x16x32_bf16 v[84:87], a[116:119], a[148:151], v[84:87]
s_add_u32 s69, s60, s70
buffer_load_dwordx4 v150, s[20:23], s69 offen lds
s_add_u32 m0, s68, 134144
s_add_u32 s69, s61, s70
v_mfma_f32_16x16x32_bf16 v[24:27], a[120:123], a[140:143], v[24:27]
buffer_load_dwordx4 v150, s[20:23], s69 offen lds
s_add_u32 m0, s65, 123648
s_add_u32 s69, s62, s71
buffer_load_dwordx4 v157, s[24:27], s69 offen lds
v_mfma_f32_16x16x32_bf16 v[56:59], a[120:123], a[144:147], v[56:59]
s_add_u32 m0, s66, 123648
s_add_u32 s69, s63, s71
buffer_load_dwordx4 v158, s[24:27], s69 offen lds
s_add_u32 m0, s67, 123648
v_mfma_f32_16x16x32_bf16 v[88:91], a[120:123], a[148:151], v[88:91]
s_add_u32 s69, s64, s71
buffer_load_dwordx4 v159, s[24:27], s69 offen lds
s_add_u32 s101, s101, 1
s_and_b32 s101, s101, 15
v_mfma_f32_16x16x32_bf16 v[28:31], a[124:127], a[140:143], v[28:31]
v_mfma_f32_16x16x32_bf16 v[60:63], a[124:127], a[144:147], v[60:63]
v_mfma_f32_16x16x32_bf16 v[92:95], a[124:127], a[148:151], v[92:95]
s_waitcnt vmcnt(42) lgkmcnt(0)
s_barrier
v_mfma_f32_16x16x32_bf16 v[0:3], a[64:67], a[128:131], v[0:3]
ds_read_b128 a[140:143], v147 offset:0
ds_read_b128 a[144:147], v147 offset:1024
v_mfma_f32_16x16x32_bf16 v[32:35], a[64:67], a[132:135], v[32:35]
ds_read_b128 a[148:151], v147 offset:2048
ds_read_b64_tr_b16 a[96:97], v144 offset:0
v_mfma_f32_16x16x32_bf16 v[64:67], a[64:67], a[136:139], v[64:67]
ds_read_b64_tr_b16 a[98:99], v144 offset:1056
ds_read_b64_tr_b16 a[100:101], v154 offset:0
v_mfma_f32_16x16x32_bf16 v[4:7], a[68:71], a[128:131], v[4:7]
ds_read_b64_tr_b16 a[102:103], v154 offset:1056
ds_read_b64_tr_b16 a[104:105], v144 offset:256
v_mfma_f32_16x16x32_bf16 v[36:39], a[68:71], a[132:135], v[36:39]
ds_read_b64_tr_b16 a[106:107], v144 offset:1312
ds_read_b64_tr_b16 a[108:109], v154 offset:256
v_mfma_f32_16x16x32_bf16 v[68:71], a[68:71], a[136:139], v[68:71]
ds_read_b64_tr_b16 a[110:111], v154 offset:1312
ds_read_b64_tr_b16 a[112:113], v144 offset:512
v_mfma_f32_16x16x32_bf16 v[8:11], a[72:75], a[128:131], v[8:11]
ds_read_b64_tr_b16 a[114:115], v144 offset:1568
ds_read_b64_tr_b16 a[116:117], v154 offset:512
v_mfma_f32_16x16x32_bf16 v[40:43], a[72:75], a[132:135], v[40:43]
ds_read_b64_tr_b16 a[118:119], v154 offset:1568
ds_read_b64_tr_b16 a[120:121], v144 offset:768
v_mfma_f32_16x16x32_bf16 v[72:75], a[72:75], a[136:139], v[72:75]
ds_read_b64_tr_b16 a[122:123], v144 offset:1824
ds_read_b64_tr_b16 a[124:125], v154 offset:768
v_mfma_f32_16x16x32_bf16 v[12:15], a[76:79], a[128:131], v[12:15]
ds_read_b64_tr_b16 a[126:127], v154 offset:1824
v_mfma_f32_16x16x32_bf16 v[44:47], a[76:79], a[132:135], v[44:47]
s_lshl_b32 s70, s101, 6
s_lshl_b32 s71, s101, 18
v_mfma_f32_16x16x32_bf16 v[76:79], a[76:79], a[136:139], v[76:79]
s_add_u32 m0, s68, 149760
s_add_u32 s69, s59, s70
v_mfma_f32_16x16x32_bf16 v[16:19], a[80:83], a[128:131], v[16:19]
buffer_load_dwordx4 v150, s[20:23], s69 offen lds
s_add_u32 m0, s68, 150784
v_mfma_f32_16x16x32_bf16 v[48:51], a[80:83], a[132:135], v[48:51]
s_add_u32 s69, s60, s70
buffer_load_dwordx4 v150, s[20:23], s69 offen lds
v_mfma_f32_16x16x32_bf16 v[80:83], a[80:83], a[136:139], v[80:83]
s_add_u32 m0, s68, 151808
s_add_u32 s69, s61, s70
v_mfma_f32_16x16x32_bf16 v[20:23], a[84:87], a[128:131], v[20:23]
buffer_load_dwordx4 v150, s[20:23], s69 offen lds
s_add_u32 m0, s65, 141312
v_mfma_f32_16x16x32_bf16 v[52:55], a[84:87], a[132:135], v[52:55]
s_add_u32 s69, s62, s71
buffer_load_dwordx4 v157, s[24:27], s69 offen lds
v_mfma_f32_16x16x32_bf16 v[84:87], a[84:87], a[136:139], v[84:87]
s_add_u32 m0, s66, 141312
s_add_u32 s69, s63, s71
v_mfma_f32_16x16x32_bf16 v[24:27], a[88:91], a[128:131], v[24:27]
buffer_load_dwordx4 v158, s[24:27], s69 offen lds
s_add_u32 m0, s67, 141312
v_mfma_f32_16x16x32_bf16 v[56:59], a[88:91], a[132:135], v[56:59]
s_add_u32 s69, s64, s71
buffer_load_dwordx4 v159, s[24:27], s69 offen lds
v_mfma_f32_16x16x32_bf16 v[88:91], a[88:91], a[136:139], v[88:91]
s_add_u32 s101, s101, 1
s_and_b32 s101, s101, 15
v_mfma_f32_16x16x32_bf16 v[28:31], a[92:95], a[128:131], v[28:31]
v_mfma_f32_16x16x32_bf16 v[60:63], a[92:95], a[132:135], v[60:63]
v_mfma_f32_16x16x32_bf16 v[92:95], a[92:95], a[136:139], v[92:95]
s_waitcnt vmcnt(42) lgkmcnt(0)
s_barrier
v_mfma_f32_16x16x32_bf16 v[0:3], a[96:99], a[140:143], v[0:3]
ds_read_b128 a[128:131], v147 offset:17664
ds_read_b128 a[132:135], v147 offset:18688
v_mfma_f32_16x16x32_bf16 v[32:35], a[96:99], a[144:147], v[32:35]
ds_read_b128 a[136:139], v147 offset:19712
ds_read_b64_tr_b16 a[64:65], v144 offset:17664
v_mfma_f32_16x16x32_bf16 v[64:67], a[96:99], a[148:151], v[64:67]
ds_read_b64_tr_b16 a[66:67], v144 offset:18720
ds_read_b64_tr_b16 a[68:69], v154 offset:17664
v_mfma_f32_16x16x32_bf16 v[4:7], a[100:103], a[140:143], v[4:7]
ds_read_b64_tr_b16 a[70:71], v154 offset:18720
ds_read_b64_tr_b16 a[72:73], v144 offset:17920
v_mfma_f32_16x16x32_bf16 v[36:39], a[100:103], a[144:147], v[36:39]
ds_read_b64_tr_b16 a[74:75], v144 offset:18976
ds_read_b64_tr_b16 a[76:77], v154 offset:17920
v_mfma_f32_16x16x32_bf16 v[68:71], a[100:103], a[148:151], v[68:71]
ds_read_b64_tr_b16 a[78:79], v154 offset:18976
ds_read_b64_tr_b16 a[80:81], v144 offset:18176
v_mfma_f32_16x16x32_bf16 v[8:11], a[104:107], a[140:143], v[8:11]
ds_read_b64_tr_b16 a[82:83], v144 offset:19232
ds_read_b64_tr_b16 a[84:85], v154 offset:18176
v_mfma_f32_16x16x32_bf16 v[40:43], a[104:107], a[144:147], v[40:43]
ds_read_b64_tr_b16 a[86:87], v154 offset:19232
ds_read_b64_tr_b16 a[88:89], v144 offset:18432
v_mfma_f32_16x16x32_bf16 v[72:75], a[104:107], a[148:151], v[72:75]
ds_read_b64_tr_b16 a[90:91], v144 offset:19488
ds_read_b64_tr_b16 a[92:93], v154 offset:18432
v_mfma_f32_16x16x32_bf16 v[12:15], a[108:111], a[140:143], v[12:15]
ds_read_b64_tr_b16 a[94:95], v154 offset:19488
v_mfma_f32_16x16x32_bf16 v[44:47], a[108:111], a[144:147], v[44:47]
buffer_load_dword v251, v250, s[40:43], s100 offen
v_mfma_f32_16x16x32_bf16 v[76:79], a[108:111], a[148:151], v[76:79]
v_mfma_f32_16x16x32_bf16 v[16:19], a[112:115], a[140:143], v[16:19]
v_mfma_f32_16x16x32_bf16 v[48:51], a[112:115], a[144:147], v[48:51]
v_mfma_f32_16x16x32_bf16 v[80:83], a[112:115], a[148:151], v[80:83]
v_mfma_f32_16x16x32_bf16 v[20:23], a[116:119], a[140:143], v[20:23]
v_mfma_f32_16x16x32_bf16 v[52:55], a[116:119], a[144:147], v[52:55]
v_mfma_f32_16x16x32_bf16 v[84:87], a[116:119], a[148:151], v[84:87]
v_mfma_f32_16x16x32_bf16 v[24:27], a[120:123], a[140:143], v[24:27]
v_mfma_f32_16x16x32_bf16 v[56:59], a[120:123], a[144:147], v[56:59]
v_mfma_f32_16x16x32_bf16 v[88:91], a[120:123], a[148:151], v[88:91]
v_mfma_f32_16x16x32_bf16 v[28:31], a[124:127], a[140:143], v[28:31]
v_mfma_f32_16x16x32_bf16 v[60:63], a[124:127], a[144:147], v[60:63]
v_mfma_f32_16x16x32_bf16 v[92:95], a[124:127], a[148:151], v[92:95]
s_waitcnt vmcnt(36) lgkmcnt(0)
s_barrier
v_mfma_f32_16x16x32_bf16 v[0:3], a[64:67], a[128:131], v[0:3]
ds_read_b128 a[140:143], v147 offset:35328
ds_read_b128 a[144:147], v147 offset:36352
v_mfma_f32_16x16x32_bf16 v[32:35], a[64:67], a[132:135], v[32:35]
ds_read_b128 a[148:151], v147 offset:37376
ds_read_b64_tr_b16 a[96:97], v144 offset:35328
v_mfma_f32_16x16x32_bf16 v[64:67], a[64:67], a[136:139], v[64:67]
ds_read_b64_tr_b16 a[98:99], v144 offset:36384
ds_read_b64_tr_b16 a[100:101], v154 offset:35328
v_mfma_f32_16x16x32_bf16 v[4:7], a[68:71], a[128:131], v[4:7]
ds_read_b64_tr_b16 a[102:103], v154 offset:36384
ds_read_b64_tr_b16 a[104:105], v144 offset:35584
v_mfma_f32_16x16x32_bf16 v[36:39], a[68:71], a[132:135], v[36:39]
ds_read_b64_tr_b16 a[106:107], v144 offset:36640
ds_read_b64_tr_b16 a[108:109], v154 offset:35584
v_mfma_f32_16x16x32_bf16 v[68:71], a[68:71], a[136:139], v[68:71]
ds_read_b64_tr_b16 a[110:111], v154 offset:36640
ds_read_b64_tr_b16 a[112:113], v144 offset:35840
v_mfma_f32_16x16x32_bf16 v[8:11], a[72:75], a[128:131], v[8:11]
ds_read_b64_tr_b16 a[114:115], v144 offset:36896
ds_read_b64_tr_b16 a[116:117], v154 offset:35840
v_mfma_f32_16x16x32_bf16 v[40:43], a[72:75], a[132:135], v[40:43]
ds_read_b64_tr_b16 a[118:119], v154 offset:36896
ds_read_b64_tr_b16 a[120:121], v144 offset:36096
v_mfma_f32_16x16x32_bf16 v[72:75], a[72:75], a[136:139], v[72:75]
ds_read_b64_tr_b16 a[122:123], v144 offset:37152
ds_read_b64_tr_b16 a[124:125], v154 offset:36096
v_mfma_f32_16x16x32_bf16 v[12:15], a[76:79], a[128:131], v[12:15]
ds_read_b64_tr_b16 a[126:127], v154 offset:37152
v_mfma_f32_16x16x32_bf16 v[44:47], a[76:79], a[132:135], v[44:47]
v_mfma_f32_16x16x32_bf16 v[76:79], a[76:79], a[136:139], v[76:79]
v_mfma_f32_16x16x32_bf16 v[16:19], a[80:83], a[128:131], v[16:19]
v_mfma_f32_16x16x32_bf16 v[48:51], a[80:83], a[132:135], v[48:51]
v_mfma_f32_16x16x32_bf16 v[80:83], a[80:83], a[136:139], v[80:83]
v_mfma_f32_16x16x32_bf16 v[20:23], a[84:87], a[128:131], v[20:23]
v_mfma_f32_16x16x32_bf16 v[52:55], a[84:87], a[132:135], v[52:55]
v_mfma_f32_16x16x32_bf16 v[84:87], a[84:87], a[136:139], v[84:87]
v_mfma_f32_16x16x32_bf16 v[24:27], a[88:91], a[128:131], v[24:27]
v_mfma_f32_16x16x32_bf16 v[56:59], a[88:91], a[132:135], v[56:59]
v_mfma_f32_16x16x32_bf16 v[88:91], a[88:91], a[136:139], v[88:91]
v_mfma_f32_16x16x32_bf16 v[28:31], a[92:95], a[128:131], v[28:31]
v_mfma_f32_16x16x32_bf16 v[60:63], a[92:95], a[132:135], v[60:63]
v_mfma_f32_16x16x32_bf16 v[92:95], a[92:95], a[136:139], v[92:95]
s_waitcnt vmcnt(30) lgkmcnt(0)
s_barrier
v_mfma_f32_16x16x32_bf16 v[0:3], a[96:99], a[140:143], v[0:3]
ds_read_b128 a[128:131], v148 offset:0
ds_read_b128 a[132:135], v148 offset:1024
v_mfma_f32_16x16x32_bf16 v[32:35], a[96:99], a[144:147], v[32:35]
ds_read_b128 a[136:139], v148 offset:2048
ds_read_b64_tr_b16 a[64:65], v145 offset:0
v_mfma_f32_16x16x32_bf16 v[64:67], a[96:99], a[148:151], v[64:67]
ds_read_b64_tr_b16 a[66:67], v145 offset:1056
ds_read_b64_tr_b16 a[68:69], v155 offset:0
v_mfma_f32_16x16x32_bf16 v[4:7], a[100:103], a[140:143], v[4:7]
ds_read_b64_tr_b16 a[70:71], v155 offset:1056
ds_read_b64_tr_b16 a[72:73], v145 offset:256
v_mfma_f32_16x16x32_bf16 v[36:39], a[100:103], a[144:147], v[36:39]
ds_read_b64_tr_b16 a[74:75], v145 offset:1312
ds_read_b64_tr_b16 a[76:77], v155 offset:256
v_mfma_f32_16x16x32_bf16 v[68:71], a[100:103], a[148:151], v[68:71]
ds_read_b64_tr_b16 a[78:79], v155 offset:1312
ds_read_b64_tr_b16 a[80:81], v145 offset:512
v_mfma_f32_16x16x32_bf16 v[8:11], a[104:107], a[140:143], v[8:11]
ds_read_b64_tr_b16 a[82:83], v145 offset:1568
ds_read_b64_tr_b16 a[84:85], v155 offset:512
v_mfma_f32_16x16x32_bf16 v[40:43], a[104:107], a[144:147], v[40:43]
ds_read_b64_tr_b16 a[86:87], v155 offset:1568
ds_read_b64_tr_b16 a[88:89], v145 offset:768
v_mfma_f32_16x16x32_bf16 v[72:75], a[104:107], a[148:151], v[72:75]
ds_read_b64_tr_b16 a[90:91], v145 offset:1824
ds_read_b64_tr_b16 a[92:93], v155 offset:768
v_mfma_f32_16x16x32_bf16 v[12:15], a[108:111], a[140:143], v[12:15]
ds_read_b64_tr_b16 a[94:95], v155 offset:1824
v_mfma_f32_16x16x32_bf16 v[44:47], a[108:111], a[144:147], v[44:47]
v_mfma_f32_16x16x32_bf16 v[76:79], a[108:111], a[148:151], v[76:79]
v_mfma_f32_16x16x32_bf16 v[16:19], a[112:115], a[140:143], v[16:19]
v_mfma_f32_16x16x32_bf16 v[48:51], a[112:115], a[144:147], v[48:51]
v_mfma_f32_16x16x32_bf16 v[80:83], a[112:115], a[148:151], v[80:83]
v_mfma_f32_16x16x32_bf16 v[20:23], a[116:119], a[140:143], v[20:23]
v_mfma_f32_16x16x32_bf16 v[52:55], a[116:119], a[144:147], v[52:55]
v_mfma_f32_16x16x32_bf16 v[84:87], a[116:119], a[148:151], v[84:87]
v_mfma_f32_16x16x32_bf16 v[24:27], a[120:123], a[140:143], v[24:27]
v_mfma_f32_16x16x32_bf16 v[56:59], a[120:123], a[144:147], v[56:59]
v_mfma_f32_16x16x32_bf16 v[88:91], a[120:123], a[148:151], v[88:91]
v_mfma_f32_16x16x32_bf16 v[28:31], a[124:127], a[140:143], v[28:31]
v_mfma_f32_16x16x32_bf16 v[60:63], a[124:127], a[144:147], v[60:63]
v_mfma_f32_16x16x32_bf16 v[92:95], a[124:127], a[148:151], v[92:95]
s_waitcnt vmcnt(24) lgkmcnt(0)
s_barrier
v_mfma_f32_16x16x32_bf16 v[0:3], a[64:67], a[128:131], v[0:3]
ds_read_b128 a[140:143], v148 offset:17664
ds_read_b128 a[144:147], v148 offset:18688
v_mfma_f32_16x16x32_bf16 v[32:35], a[64:67], a[132:135], v[32:35]
ds_read_b128 a[148:151], v148 offset:19712
ds_read_b64_tr_b16 a[96:97], v145 offset:17664
v_mfma_f32_16x16x32_bf16 v[64:67], a[64:67], a[136:139], v[64:67]
ds_read_b64_tr_b16 a[98:99], v145 offset:18720
ds_read_b64_tr_b16 a[100:101], v155 offset:17664
v_mfma_f32_16x16x32_bf16 v[4:7], a[68:71], a[128:131], v[4:7]
ds_read_b64_tr_b16 a[102:103], v155 offset:18720
ds_read_b64_tr_b16 a[104:105], v145 offset:17920
v_mfma_f32_16x16x32_bf16 v[36:39], a[68:71], a[132:135], v[36:39]
ds_read_b64_tr_b16 a[106:107], v145 offset:18976
ds_read_b64_tr_b16 a[108:109], v155 offset:17920
v_mfma_f32_16x16x32_bf16 v[68:71], a[68:71], a[136:139], v[68:71]
ds_read_b64_tr_b16 a[110:111], v155 offset:18976
ds_read_b64_tr_b16 a[112:113], v145 offset:18176
v_mfma_f32_16x16x32_bf16 v[8:11], a[72:75], a[128:131], v[8:11]
ds_read_b64_tr_b16 a[114:115], v145 offset:19232
ds_read_b64_tr_b16 a[116:117], v155 offset:18176
v_mfma_f32_16x16x32_bf16 v[40:43], a[72:75], a[132:135], v[40:43]
ds_read_b64_tr_b16 a[118:119], v155 offset:19232
ds_read_b64_tr_b16 a[120:121], v145 offset:18432
v_mfma_f32_16x16x32_bf16 v[72:75], a[72:75], a[136:139], v[72:75]
ds_read_b64_tr_b16 a[122:123], v145 offset:19488
ds_read_b64_tr_b16 a[124:125], v155 offset:18432
v_mfma_f32_16x16x32_bf16 v[12:15], a[76:79], a[128:131], v[12:15]
ds_read_b64_tr_b16 a[126:127], v155 offset:19488
v_mfma_f32_16x16x32_bf16 v[44:47], a[76:79], a[132:135], v[44:47]
v_mfma_f32_16x16x32_bf16 v[76:79], a[76:79], a[136:139], v[76:79]
v_mfma_f32_16x16x32_bf16 v[16:19], a[80:83], a[128:131], v[16:19]
v_mfma_f32_16x16x32_bf16 v[48:51], a[80:83], a[132:135], v[48:51]
v_mfma_f32_16x16x32_bf16 v[80:83], a[80:83], a[136:139], v[80:83]
v_mfma_f32_16x16x32_bf16 v[20:23], a[84:87], a[128:131], v[20:23]
v_mfma_f32_16x16x32_bf16 v[52:55], a[84:87], a[132:135], v[52:55]
v_mfma_f32_16x16x32_bf16 v[84:87], a[84:87], a[136:139], v[84:87]
v_mfma_f32_16x16x32_bf16 v[24:27], a[88:91], a[128:131], v[24:27]
v_mfma_f32_16x16x32_bf16 v[56:59], a[88:91], a[132:135], v[56:59]
v_mfma_f32_16x16x32_bf16 v[88:91], a[88:91], a[136:139], v[88:91]
v_mfma_f32_16x16x32_bf16 v[28:31], a[92:95], a[128:131], v[28:31]
v_mfma_f32_16x16x32_bf16 v[60:63], a[92:95], a[132:135], v[60:63]
v_mfma_f32_16x16x32_bf16 v[92:95], a[92:95], a[136:139], v[92:95]
s_waitcnt vmcnt(18) lgkmcnt(0)
s_barrier
v_mfma_f32_16x16x32_bf16 v[0:3], a[96:99], a[140:143], v[0:3]
ds_read_b128 a[128:131], v148 offset:35328
ds_read_b128 a[132:135], v148 offset:36352
v_mfma_f32_16x16x32_bf16 v[32:35], a[96:99], a[144:147], v[32:35]
ds_read_b128 a[136:139], v148 offset:37376
ds_read_b64_tr_b16 a[64:65], v145 offset:35328
v_mfma_f32_16x16x32_bf16 v[64:67], a[96:99], a[148:151], v[64:67]
ds_read_b64_tr_b16 a[66:67], v145 offset:36384
ds_read_b64_tr_b16 a[68:69], v155 offset:35328
v_mfma_f32_16x16x32_bf16 v[4:7], a[100:103], a[140:143], v[4:7]
ds_read_b64_tr_b16 a[70:71], v155 offset:36384
ds_read_b64_tr_b16 a[72:73], v145 offset:35584
v_mfma_f32_16x16x32_bf16 v[36:39], a[100:103], a[144:147], v[36:39]
ds_read_b64_tr_b16 a[74:75], v145 offset:36640
ds_read_b64_tr_b16 a[76:77], v155 offset:35584
v_mfma_f32_16x16x32_bf16 v[68:71], a[100:103], a[148:151], v[68:71]
ds_read_b64_tr_b16 a[78:79], v155 offset:36640
ds_read_b64_tr_b16 a[80:81], v145 offset:35840
v_mfma_f32_16x16x32_bf16 v[8:11], a[104:107], a[140:143], v[8:11]
ds_read_b64_tr_b16 a[82:83], v145 offset:36896
ds_read_b64_tr_b16 a[84:85], v155 offset:35840
v_mfma_f32_16x16x32_bf16 v[40:43], a[104:107], a[144:147], v[40:43]
ds_read_b64_tr_b16 a[86:87], v155 offset:36896
ds_read_b64_tr_b16 a[88:89], v145 offset:36096
v_mfma_f32_16x16x32_bf16 v[72:75], a[104:107], a[148:151], v[72:75]
ds_read_b64_tr_b16 a[90:91], v145 offset:37152
ds_read_b64_tr_b16 a[92:93], v155 offset:36096
v_mfma_f32_16x16x32_bf16 v[12:15], a[108:111], a[140:143], v[12:15]
ds_read_b64_tr_b16 a[94:95], v155 offset:37152
v_mfma_f32_16x16x32_bf16 v[44:47], a[108:111], a[144:147], v[44:47]
v_mfma_f32_16x16x32_bf16 v[76:79], a[108:111], a[148:151], v[76:79]
v_mfma_f32_16x16x32_bf16 v[16:19], a[112:115], a[140:143], v[16:19]
v_mfma_f32_16x16x32_bf16 v[48:51], a[112:115], a[144:147], v[48:51]
v_mfma_f32_16x16x32_bf16 v[80:83], a[112:115], a[148:151], v[80:83]
v_mfma_f32_16x16x32_bf16 v[20:23], a[116:119], a[140:143], v[20:23]
v_mfma_f32_16x16x32_bf16 v[52:55], a[116:119], a[144:147], v[52:55]
v_mfma_f32_16x16x32_bf16 v[84:87], a[116:119], a[148:151], v[84:87]
v_mfma_f32_16x16x32_bf16 v[24:27], a[120:123], a[140:143], v[24:27]
v_mfma_f32_16x16x32_bf16 v[56:59], a[120:123], a[144:147], v[56:59]
v_mfma_f32_16x16x32_bf16 v[88:91], a[120:123], a[148:151], v[88:91]
v_mfma_f32_16x16x32_bf16 v[28:31], a[124:127], a[140:143], v[28:31]
v_mfma_f32_16x16x32_bf16 v[60:63], a[124:127], a[144:147], v[60:63]
v_mfma_f32_16x16x32_bf16 v[92:95], a[124:127], a[148:151], v[92:95]
s_waitcnt vmcnt(12) lgkmcnt(0)
s_barrier
v_mfma_f32_16x16x32_bf16 v[0:3], a[64:67], a[128:131], v[0:3]
ds_read_b128 a[140:143], v149 offset:0
ds_read_b128 a[144:147], v149 offset:1024
v_mfma_f32_16x16x32_bf16 v[32:35], a[64:67], a[132:135], v[32:35]
ds_read_b128 a[148:151], v149 offset:2048
ds_read_b64_tr_b16 a[96:97], v146 offset:0
v_mfma_f32_16x16x32_bf16 v[64:67], a[64:67], a[136:139], v[64:67]
ds_read_b64_tr_b16 a[98:99], v146 offset:1056
ds_read_b64_tr_b16 a[100:101], v156 offset:0
v_mfma_f32_16x16x32_bf16 v[4:7], a[68:71], a[128:131], v[4:7]
ds_read_b64_tr_b16 a[102:103], v156 offset:1056
ds_read_b64_tr_b16 a[104:105], v146 offset:256
v_mfma_f32_16x16x32_bf16 v[36:39], a[68:71], a[132:135], v[36:39]
ds_read_b64_tr_b16 a[106:107], v146 offset:1312
ds_read_b64_tr_b16 a[108:109], v156 offset:256
v_mfma_f32_16x16x32_bf16 v[68:71], a[68:71], a[136:139], v[68:71]
ds_read_b64_tr_b16 a[110:111], v156 offset:1312
ds_read_b64_tr_b16 a[112:113], v146 offset:512
v_mfma_f32_16x16x32_bf16 v[8:11], a[72:75], a[128:131], v[8:11]
ds_read_b64_tr_b16 a[114:115], v146 offset:1568
ds_read_b64_tr_b16 a[116:117], v156 offset:512
v_mfma_f32_16x16x32_bf16 v[40:43], a[72:75], a[132:135], v[40:43]
ds_read_b64_tr_b16 a[118:119], v156 offset:1568
ds_read_b64_tr_b16 a[120:121], v146 offset:768
v_mfma_f32_16x16x32_bf16 v[72:75], a[72:75], a[136:139], v[72:75]
ds_read_b64_tr_b16 a[122:123], v146 offset:1824
ds_read_b64_tr_b16 a[124:125], v156 offset:768
v_mfma_f32_16x16x32_bf16 v[12:15], a[76:79], a[128:131], v[12:15]
ds_read_b64_tr_b16 a[126:127], v156 offset:1824
v_mfma_f32_16x16x32_bf16 v[44:47], a[76:79], a[132:135], v[44:47]
v_mfma_f32_16x16x32_bf16 v[76:79], a[76:79], a[136:139], v[76:79]
v_mfma_f32_16x16x32_bf16 v[16:19], a[80:83], a[128:131], v[16:19]
v_mfma_f32_16x16x32_bf16 v[48:51], a[80:83], a[132:135], v[48:51]
v_mfma_f32_16x16x32_bf16 v[80:83], a[80:83], a[136:139], v[80:83]
v_mfma_f32_16x16x32_bf16 v[20:23], a[84:87], a[128:131], v[20:23]
v_mfma_f32_16x16x32_bf16 v[52:55], a[84:87], a[132:135], v[52:55]
v_mfma_f32_16x16x32_bf16 v[84:87], a[84:87], a[136:139], v[84:87]
v_mfma_f32_16x16x32_bf16 v[24:27], a[88:91], a[128:131], v[24:27]
v_mfma_f32_16x16x32_bf16 v[56:59], a[88:91], a[132:135], v[56:59]
v_mfma_f32_16x16x32_bf16 v[88:91], a[88:91], a[136:139], v[88:91]
v_mfma_f32_16x16x32_bf16 v[28:31], a[92:95], a[128:131], v[28:31]
v_mfma_f32_16x16x32_bf16 v[60:63], a[92:95], a[132:135], v[60:63]
v_mfma_f32_16x16x32_bf16 v[92:95], a[92:95], a[136:139], v[92:95]
s_waitcnt vmcnt(6) lgkmcnt(0)
s_barrier
v_mfma_f32_16x16x32_bf16 v[0:3], a[96:99], a[140:143], v[0:3]
ds_read_b128 a[128:131], v149 offset:17664
ds_read_b128 a[132:135], v149 offset:18688
v_mfma_f32_16x16x32_bf16 v[32:35], a[96:99], a[144:147], v[32:35]
ds_read_b128 a[136:139], v149 offset:19712
ds_read_b64_tr_b16 a[64:65], v146 offset:17664
v_mfma_f32_16x16x32_bf16 v[64:67], a[96:99], a[148:151], v[64:67]
ds_read_b64_tr_b16 a[66:67], v146 offset:18720
ds_read_b64_tr_b16 a[68:69], v156 offset:17664
v_mfma_f32_16x16x32_bf16 v[4:7], a[100:103], a[140:143], v[4:7]
ds_read_b64_tr_b16 a[70:71], v156 offset:18720
ds_read_b64_tr_b16 a[72:73], v146 offset:17920
v_mfma_f32_16x16x32_bf16 v[36:39], a[100:103], a[144:147], v[36:39]
ds_read_b64_tr_b16 a[74:75], v146 offset:18976
ds_read_b64_tr_b16 a[76:77], v156 offset:17920
v_mfma_f32_16x16x32_bf16 v[68:71], a[100:103], a[148:151], v[68:71]
ds_read_b64_tr_b16 a[78:79], v156 offset:18976
ds_read_b64_tr_b16 a[80:81], v146 offset:18176
v_mfma_f32_16x16x32_bf16 v[8:11], a[104:107], a[140:143], v[8:11]
ds_read_b64_tr_b16 a[82:83], v146 offset:19232
ds_read_b64_tr_b16 a[84:85], v156 offset:18176
v_mfma_f32_16x16x32_bf16 v[40:43], a[104:107], a[144:147], v[40:43]
ds_read_b64_tr_b16 a[86:87], v156 offset:19232
ds_read_b64_tr_b16 a[88:89], v146 offset:18432
v_mfma_f32_16x16x32_bf16 v[72:75], a[104:107], a[148:151], v[72:75]
ds_read_b64_tr_b16 a[90:91], v146 offset:19488
ds_read_b64_tr_b16 a[92:93], v156 offset:18432
v_mfma_f32_16x16x32_bf16 v[12:15], a[108:111], a[140:143], v[12:15]
ds_read_b64_tr_b16 a[94:95], v156 offset:19488
v_mfma_f32_16x16x32_bf16 v[44:47], a[108:111], a[144:147], v[44:47]
v_mfma_f32_16x16x32_bf16 v[76:79], a[108:111], a[148:151], v[76:79]
v_mfma_f32_16x16x32_bf16 v[16:19], a[112:115], a[140:143], v[16:19]
v_mfma_f32_16x16x32_bf16 v[48:51], a[112:115], a[144:147], v[48:51]
v_mfma_f32_16x16x32_bf16 v[80:83], a[112:115], a[148:151], v[80:83]
v_mfma_f32_16x16x32_bf16 v[20:23], a[116:119], a[140:143], v[20:23]
v_mfma_f32_16x16x32_bf16 v[52:55], a[116:119], a[144:147], v[52:55]
v_mfma_f32_16x16x32_bf16 v[84:87], a[116:119], a[148:151], v[84:87]
v_mfma_f32_16x16x32_bf16 v[24:27], a[120:123], a[140:143], v[24:27]
v_mfma_f32_16x16x32_bf16 v[56:59], a[120:123], a[144:147], v[56:59]
v_mfma_f32_16x16x32_bf16 v[88:91], a[120:123], a[148:151], v[88:91]
v_mfma_f32_16x16x32_bf16 v[28:31], a[124:127], a[140:143], v[28:31]
v_mfma_f32_16x16x32_bf16 v[60:63], a[124:127], a[144:147], v[60:63]
v_mfma_f32_16x16x32_bf16 v[92:95], a[124:127], a[148:151], v[92:95]
s_waitcnt vmcnt(0) lgkmcnt(0)
s_barrier
v_mfma_f32_16x16x32_bf16 v[0:3], a[64:67], a[128:131], v[0:3]
ds_read_b128 a[140:143], v149 offset:35328
ds_read_b128 a[144:147], v149 offset:36352
v_mfma_f32_16x16x32_bf16 v[32:35], a[64:67], a[132:135], v[32:35]
ds_read_b128 a[148:151], v149 offset:37376
ds_read_b64_tr_b16 a[96:97], v146 offset:35328
v_mfma_f32_16x16x32_bf16 v[64:67], a[64:67], a[136:139], v[64:67]
ds_read_b64_tr_b16 a[98:99], v146 offset:36384
ds_read_b64_tr_b16 a[100:101], v156 offset:35328
v_mfma_f32_16x16x32_bf16 v[4:7], a[68:71], a[128:131], v[4:7]
ds_read_b64_tr_b16 a[102:103], v156 offset:36384
ds_read_b64_tr_b16 a[104:105], v146 offset:35584
v_mfma_f32_16x16x32_bf16 v[36:39], a[68:71], a[132:135], v[36:39]
ds_read_b64_tr_b16 a[106:107], v146 offset:36640
ds_read_b64_tr_b16 a[108:109], v156 offset:35584
v_mfma_f32_16x16x32_bf16 v[68:71], a[68:71], a[136:139], v[68:71]
ds_read_b64_tr_b16 a[110:111], v156 offset:36640
ds_read_b64_tr_b16 a[112:113], v146 offset:35840
v_mfma_f32_16x16x32_bf16 v[8:11], a[72:75], a[128:131], v[8:11]
ds_read_b64_tr_b16 a[114:115], v146 offset:36896
ds_read_b64_tr_b16 a[116:117], v156 offset:35840
v_mfma_f32_16x16x32_bf16 v[40:43], a[72:75], a[132:135], v[40:43]
ds_read_b64_tr_b16 a[118:119], v156 offset:36896
ds_read_b64_tr_b16 a[120:121], v146 offset:36096
v_mfma_f32_16x16x32_bf16 v[72:75], a[72:75], a[136:139], v[72:75]
ds_read_b64_tr_b16 a[122:123], v146 offset:37152
ds_read_b64_tr_b16 a[124:125], v156 offset:36096
v_mfma_f32_16x16x32_bf16 v[12:15], a[76:79], a[128:131], v[12:15]
ds_read_b64_tr_b16 a[126:127], v156 offset:37152
v_mfma_f32_16x16x32_bf16 v[44:47], a[76:79], a[132:135], v[44:47]
v_mfma_f32_16x16x32_bf16 v[76:79], a[76:79], a[136:139], v[76:79]
v_mfma_f32_16x16x32_bf16 v[16:19], a[80:83], a[128:131], v[16:19]
v_mfma_f32_16x16x32_bf16 v[48:51], a[80:83], a[132:135], v[48:51]
v_mfma_f32_16x16x32_bf16 v[80:83], a[80:83], a[136:139], v[80:83]
v_mfma_f32_16x16x32_bf16 v[20:23], a[84:87], a[128:131], v[20:23]
v_mfma_f32_16x16x32_bf16 v[52:55], a[84:87], a[132:135], v[52:55]
v_mfma_f32_16x16x32_bf16 v[84:87], a[84:87], a[136:139], v[84:87]
v_mfma_f32_16x16x32_bf16 v[24:27], a[88:91], a[128:131], v[24:27]
v_mfma_f32_16x16x32_bf16 v[56:59], a[88:91], a[132:135], v[56:59]
v_mfma_f32_16x16x32_bf16 v[88:91], a[88:91], a[136:139], v[88:91]
v_mfma_f32_16x16x32_bf16 v[28:31], a[92:95], a[128:131], v[28:31]
v_mfma_f32_16x16x32_bf16 v[60:63], a[92:95], a[132:135], v[60:63]
v_mfma_f32_16x16x32_bf16 v[92:95], a[92:95], a[136:139], v[92:95]
s_waitcnt lgkmcnt(0)
v_mfma_f32_16x16x32_bf16 v[0:3], a[96:99], a[140:143], v[0:3]
v_mfma_f32_16x16x32_bf16 v[32:35], a[96:99], a[144:147], v[32:35]
v_mfma_f32_16x16x32_bf16 v[64:67], a[96:99], a[148:151], v[64:67]
v_mfma_f32_16x16x32_bf16 v[4:7], a[100:103], a[140:143], v[4:7]
v_mfma_f32_16x16x32_bf16 v[36:39], a[100:103], a[144:147], v[36:39]
v_mfma_f32_16x16x32_bf16 v[68:71], a[100:103], a[148:151], v[68:71]
v_mfma_f32_16x16x32_bf16 v[8:11], a[104:107], a[140:143], v[8:11]
v_mfma_f32_16x16x32_bf16 v[40:43], a[104:107], a[144:147], v[40:43]
v_mfma_f32_16x16x32_bf16 v[72:75], a[104:107], a[148:151], v[72:75]
v_mfma_f32_16x16x32_bf16 v[12:15], a[108:111], a[140:143], v[12:15]
v_mfma_f32_16x16x32_bf16 v[44:47], a[108:111], a[144:147], v[44:47]
v_mfma_f32_16x16x32_bf16 v[76:79], a[108:111], a[148:151], v[76:79]
v_mfma_f32_16x16x32_bf16 v[16:19], a[112:115], a[140:143], v[16:19]
v_mfma_f32_16x16x32_bf16 v[48:51], a[112:115], a[144:147], v[48:51]
v_mfma_f32_16x16x32_bf16 v[80:83], a[112:115], a[148:151], v[80:83]
v_mfma_f32_16x16x32_bf16 v[20:23], a[116:119], a[140:143], v[20:23]
v_mfma_f32_16x16x32_bf16 v[52:55], a[116:119], a[144:147], v[52:55]
v_mfma_f32_16x16x32_bf16 v[84:87], a[116:119], a[148:151], v[84:87]
v_mfma_f32_16x16x32_bf16 v[24:27], a[120:123], a[140:143], v[24:27]
v_mfma_f32_16x16x32_bf16 v[56:59], a[120:123], a[144:147], v[56:59]
v_mfma_f32_16x16x32_bf16 v[88:91], a[120:123], a[148:151], v[88:91]
v_mfma_f32_16x16x32_bf16 v[28:31], a[124:127], a[140:143], v[28:31]
v_mfma_f32_16x16x32_bf16 v[60:63], a[124:127], a[144:147], v[60:63]
v_mfma_f32_16x16x32_bf16 v[92:95], a[124:127], a[148:151], v[92:95]
s_cmp_lg_u32 s3, 0
s_cbranch_scc1 L_nw4
s_add_u32 s100, s100, 24576
buffer_load_dword v251, v250, s[40:43], s100 offen
L_nw4:
v_bfe_u32 v238, v236, 4, 1
v_cmp_eq_u32 vcc, 1, v238
s_nop 7
v_pk_mul_f32 v[0:1], v[0:1], v[152:153]
v_pk_mul_f32 v[2:3], v[2:3], v[152:153]
v_pk_mul_f32 v[4:5], v[4:5], v[152:153]
v_pk_mul_f32 v[6:7], v[6:7], v[152:153]
v_cvt_pk_bf16_f32 v0, v0, v1
v_cvt_pk_bf16_f32 v1, v2, v3
v_cvt_pk_bf16_f32 v4, v4, v5
v_cvt_pk_bf16_f32 v5, v6, v7
v_cndmask_b32 v96, v0, v4, vcc
v_cndmask_b32 v97, v1, v5, vcc
v_cndmask_b32 v98, v4, v0, vcc
v_cndmask_b32 v99, v5, v1, vcc
v_pk_mul_f32 v[8:9], v[8:9], v[152:153]
v_pk_mul_f32 v[10:11], v[10:11], v[152:153]
v_pk_mul_f32 v[12:13], v[12:13], v[152:153]
v_pk_mul_f32 v[14:15], v[14:15], v[152:153]
v_cvt_pk_bf16_f32 v8, v8, v9
v_cvt_pk_bf16_f32 v9, v10, v11
v_cvt_pk_bf16_f32 v12, v12, v13
v_cvt_pk_bf16_f32 v13, v14, v15
v_cndmask_b32 v100, v8, v12, vcc
v_cndmask_b32 v101, v9, v13, vcc
v_cndmask_b32 v102, v12, v8, vcc
v_cndmask_b32 v103, v13, v9, vcc
v_pk_mul_f32 v[16:17], v[16:17], v[152:153]
v_pk_mul_f32 v[18:19], v[18:19], v[152:153]
v_pk_mul_f32 v[20:21], v[20:21], v[152:153]
v_pk_mul_f32 v[22:23], v[22:23], v[152:153]
v_cvt_pk_bf16_f32 v16, v16, v17
v_cvt_pk_bf16_f32 v17, v18, v19
v_cvt_pk_bf16_f32 v20, v20, v21
v_cvt_pk_bf16_f32 v21, v22, v23
v_cndmask_b32 v104, v16, v20, vcc
v_cndmask_b32 v105, v17, v21, vcc
v_cndmask_b32 v106, v20, v16, vcc
v_cndmask_b32 v107, v21, v17, vcc
v_pk_mul_f32 v[24:25], v[24:25], v[152:153]
v_pk_mul_f32 v[26:27], v[26:27], v[152:153]
v_pk_mul_f32 v[28:29], v[28:29], v[152:153]
v_pk_mul_f32 v[30:31], v[30:31], v[152:153]
v_cvt_pk_bf16_f32 v24, v24, v25
v_cvt_pk_bf16_f32 v25, v26, v27
v_cvt_pk_bf16_f32 v28, v28, v29
v_cvt_pk_bf16_f32 v29, v30, v31
v_cndmask_b32 v108, v24, v28, vcc
v_cndmask_b32 v109, v25, v29, vcc
v_cndmask_b32 v110, v28, v24, vcc
v_cndmask_b32 v111, v29, v25, vcc
v_pk_mul_f32 v[32:33], v[32:33], v[152:153]
v_pk_mul_f32 v[34:35], v[34:35], v[152:153]
v_pk_mul_f32 v[36:37], v[36:37], v[152:153]
v_pk_mul_f32 v[38:39], v[38:39], v[152:153]
v_cvt_pk_bf16_f32 v32, v32, v33
v_cvt_pk_bf16_f32 v33, v34, v35
v_cvt_pk_bf16_f32 v36, v36, v37
v_cvt_pk_bf16_f32 v37, v38, v39
v_cndmask_b32 v112, v32, v36, vcc
v_cndmask_b32 v113, v33, v37, vcc
v_cndmask_b32 v114, v36, v32, vcc
v_cndmask_b32 v115, v37, v33, vcc
v_pk_mul_f32 v[40:41], v[40:41], v[152:153]
v_pk_mul_f32 v[42:43], v[42:43], v[152:153]
v_pk_mul_f32 v[44:45], v[44:45], v[152:153]
v_pk_mul_f32 v[46:47], v[46:47], v[152:153]
v_cvt_pk_bf16_f32 v40, v40, v41
v_cvt_pk_bf16_f32 v41, v42, v43
v_cvt_pk_bf16_f32 v44, v44, v45
v_cvt_pk_bf16_f32 v45, v46, v47
v_cndmask_b32 v116, v40, v44, vcc
v_cndmask_b32 v117, v41, v45, vcc
v_cndmask_b32 v118, v44, v40, vcc
v_cndmask_b32 v119, v45, v41, vcc
v_pk_mul_f32 v[48:49], v[48:49], v[152:153]
v_pk_mul_f32 v[50:51], v[50:51], v[152:153]
v_pk_mul_f32 v[52:53], v[52:53], v[152:153]
v_pk_mul_f32 v[54:55], v[54:55], v[152:153]
v_cvt_pk_bf16_f32 v48, v48, v49
v_cvt_pk_bf16_f32 v49, v50, v51
v_cvt_pk_bf16_f32 v52, v52, v53
v_cvt_pk_bf16_f32 v53, v54, v55
v_cndmask_b32 v120, v48, v52, vcc
v_cndmask_b32 v121, v49, v53, vcc
v_cndmask_b32 v122, v52, v48, vcc
v_cndmask_b32 v123, v53, v49, vcc
v_pk_mul_f32 v[56:57], v[56:57], v[152:153]
v_pk_mul_f32 v[58:59], v[58:59], v[152:153]
v_pk_mul_f32 v[60:61], v[60:61], v[152:153]
v_pk_mul_f32 v[62:63], v[62:63], v[152:153]
v_cvt_pk_bf16_f32 v56, v56, v57
v_cvt_pk_bf16_f32 v57, v58, v59
v_cvt_pk_bf16_f32 v60, v60, v61
v_cvt_pk_bf16_f32 v61, v62, v63
v_cndmask_b32 v124, v56, v60, vcc
v_cndmask_b32 v125, v57, v61, vcc
v_cndmask_b32 v126, v60, v56, vcc
v_cndmask_b32 v127, v61, v57, vcc
v_pk_mul_f32 v[64:65], v[64:65], v[152:153]
v_pk_mul_f32 v[66:67], v[66:67], v[152:153]
v_pk_mul_f32 v[68:69], v[68:69], v[152:153]
v_pk_mul_f32 v[70:71], v[70:71], v[152:153]
v_cvt_pk_bf16_f32 v64, v64, v65
v_cvt_pk_bf16_f32 v65, v66, v67
v_cvt_pk_bf16_f32 v68, v68, v69
v_cvt_pk_bf16_f32 v69, v70, v71
v_cndmask_b32 v128, v64, v68, vcc
v_cndmask_b32 v129, v65, v69, vcc
v_cndmask_b32 v130, v68, v64, vcc
v_cndmask_b32 v131, v69, v65, vcc
v_pk_mul_f32 v[72:73], v[72:73], v[152:153]
v_pk_mul_f32 v[74:75], v[74:75], v[152:153]
v_pk_mul_f32 v[76:77], v[76:77], v[152:153]
v_pk_mul_f32 v[78:79], v[78:79], v[152:153]
v_cvt_pk_bf16_f32 v72, v72, v73
v_cvt_pk_bf16_f32 v73, v74, v75
v_cvt_pk_bf16_f32 v76, v76, v77
v_cvt_pk_bf16_f32 v77, v78, v79
v_cndmask_b32 v132, v72, v76, vcc
v_cndmask_b32 v133, v73, v77, vcc
v_cndmask_b32 v134, v76, v72, vcc
v_cndmask_b32 v135, v77, v73, vcc
v_pk_mul_f32 v[80:81], v[80:81], v[152:153]
v_pk_mul_f32 v[82:83], v[82:83], v[152:153]
v_pk_mul_f32 v[84:85], v[84:85], v[152:153]
v_pk_mul_f32 v[86:87], v[86:87], v[152:153]
v_cvt_pk_bf16_f32 v80, v80, v81
v_cvt_pk_bf16_f32 v81, v82, v83
v_cvt_pk_bf16_f32 v84, v84, v85
v_cvt_pk_bf16_f32 v85, v86, v87
v_cndmask_b32 v136, v80, v84, vcc
v_cndmask_b32 v137, v81, v85, vcc
v_cndmask_b32 v138, v84, v80, vcc
v_cndmask_b32 v139, v85, v81, vcc
v_pk_mul_f32 v[88:89], v[88:89], v[152:153]
v_pk_mul_f32 v[90:91], v[90:91], v[152:153]
v_pk_mul_f32 v[92:93], v[92:93], v[152:153]
v_pk_mul_f32 v[94:95], v[94:95], v[152:153]
v_cvt_pk_bf16_f32 v88, v88, v89
v_cvt_pk_bf16_f32 v89, v90, v91
v_cvt_pk_bf16_f32 v92, v92, v93
v_cvt_pk_bf16_f32 v93, v94, v95
v_cndmask_b32 v140, v88, v92, vcc
v_cndmask_b32 v141, v89, v93, vcc
v_cndmask_b32 v142, v92, v88, vcc
v_cndmask_b32 v143, v93, v89, vcc
s_mov_b32 s51, 0
s_mov_b32 s52, 158976
s_mov_b32 s53, 158976
v_add_u32 v232, s51, v234
v_add_u32 v233, s51, v235
s_barrier
ds_read_b128 a[0:3], v232 offset:0
ds_read_b128 a[4:7], v232 offset:256
ds_read_b128 a[8:11], v232 offset:512
ds_read_b128 a[12:15], v232 offset:768
ds_read_b128 a[16:19], v232 offset:4224
ds_read_b128 a[20:23], v232 offset:4480
ds_read_b128 a[24:27], v232 offset:4736
ds_read_b128 a[28:31], v232 offset:4992
s_waitcnt lgkmcnt(0)
v_mfma_f32_16x16x32_bf16 v[144:147], a[0:3], v[96:99], 0
v_mfma_f32_16x16x32_bf16 v[144:147], a[4:7], v[100:103], v[144:147]
v_mfma_f32_16x16x32_bf16 v[144:147], a[8:11], v[104:107], v[144:147]
v_mfma_f32_16x16x32_bf16 v[144:147], a[12:15], v[108:111], v[144:147]
v_mfma_f32_16x16x32_bf16 v[148:151], a[16:19], v[96:99], 0
v_mfma_f32_16x16x32_bf16 v[148:151], a[20:23], v[100:103], v[148:151]
v_mfma_f32_16x16x32_bf16 v[148:151], a[24:27], v[104:107], v[148:151]
v_mfma_f32_16x16x32_bf16 v[148:151], a[28:31], v[108:111], v[148:151]
v_mfma_f32_16x16x32_bf16 v[152:155], a[0:3], v[112:115], 0
v_mfma_f32_16x16x32_bf16 v[152:155], a[4:7], v[116:119], v[152:155]
v_mfma_f32_16x16x32_bf16 v[152:155], a[8:11], v[120:123], v[152:155]
v_mfma_f32_16x16x32_bf16 v[152:155], a[12:15], v[124:127], v[152:155]
v_mfma_f32_16x16x32_bf16 v[156:159], a[16:19], v[112:115], 0
v_mfma_f32_16x16x32_bf16 v[156:159], a[20:23], v[116:119], v[156:159]
v_mfma_f32_16x16x32_bf16 v[156:159], a[24:27], v[120:123], v[156:159]
v_mfma_f32_16x16x32_bf16 v[156:159], a[28:31], v[124:127], v[156:159]
v_mfma_f32_16x16x32_bf16 v[160:163], a[0:3], v[128:131], 0
v_mfma_f32_16x16x32_bf16 v[160:163], a[4:7], v[132:135], v[160:163]
v_mfma_f32_16x16x32_bf16 v[160:163], a[8:11], v[136:139], v[160:163]
v_mfma_f32_16x16x32_bf16 v[160:163], a[12:15], v[140:143], v[160:163]
v_mfma_f32_16x16x32_bf16 v[164:167], a[16:19], v[128:131], 0
v_mfma_f32_16x16x32_bf16 v[164:167], a[20:23], v[132:135], v[164:167]
v_mfma_f32_16x16x32_bf16 v[164:167], a[24:27], v[136:139], v[164:167]
v_mfma_f32_16x16x32_bf16 v[164:167], a[28:31], v[140:143], v[164:167]
s_add_u32 s51, s51, 17664
s_cmp_eq_u32 s51, s52
s_cselect_b32 s51, 0, s51
s_cselect_b32 s52, s53, s52
s_cselect_b32 s53, 88320, s53
v_add_u32 v232, s51, v234
v_add_u32 v233, s51, v235
s_barrier
ds_read_b128 a[0:3], v232 offset:0
ds_read_b128 a[4:7], v232 offset:256
ds_read_b128 a[8:11], v232 offset:512
ds_read_b128 a[12:15], v232 offset:768
ds_read_b128 a[16:19], v232 offset:4224
ds_read_b128 a[20:23], v232 offset:4480
ds_read_b128 a[24:27], v232 offset:4736
ds_read_b128 a[28:31], v232 offset:4992
ds_read_b64_tr_b16 a[32:33], v233 offset:0
ds_read_b64_tr_b16 a[34:35], v233 offset:4224
ds_read_b64_tr_b16 a[36:37], v233 offset:32
ds_read_b64_tr_b16 a[38:39], v233 offset:4256
ds_read_b64_tr_b16 a[40:41], v233 offset:256
ds_read_b64_tr_b16 a[42:43], v233 offset:4480
ds_read_b64_tr_b16 a[44:45], v233 offset:288
ds_read_b64_tr_b16 a[46:47], v233 offset:4512
ds_read_b64_tr_b16 a[48:49], v233 offset:512
ds_read_b64_tr_b16 a[50:51], v233 offset:4736
ds_read_b64_tr_b16 a[52:53], v233 offset:544
ds_read_b64_tr_b16 a[54:55], v233 offset:4768
ds_read_b64_tr_b16 a[56:57], v233 offset:768
ds_read_b64_tr_b16 a[58:59], v233 offset:4992
ds_read_b64_tr_b16 a[60:61], v233 offset:800
ds_read_b64_tr_b16 a[62:63], v233 offset:5024
v_max3_f32 v204, v144, v145, v146
v_max3_f32 v204, v204, v147, v148
v_max3_f32 v204, v204, v149, v150
v_max_f32 v204, v204, v151
v_max3_f32 v208, v152, v153, v154
v_max3_f32 v208, v208, v155, v156
v_max3_f32 v208, v208, v157, v158
v_max_f32 v208, v208, v159
v_max3_f32 v212, v160, v161, v162
v_max3_f32 v212, v212, v163, v164
v_max3_f32 v212, v212, v165, v166
v_max_f32 v212, v212, v167
v_mov_b32 v246, 158992
ds_read_b32 v247, v246
v_xor_b32 v238, 16, v236
v_lshlrev_b32 v238, 2, v238
v_xor_b32 v239, 32, v236
v_lshlrev_b32 v239, 2, v239
ds_bpermute_b32 v242, v238, v204
ds_bpermute_b32 v243, v238, v208
ds_bpermute_b32 v244, v238, v212
s_waitcnt lgkmcnt(0)
v_max_f32 v204, v204, v242
v_max_f32 v208, v208, v243
v_max_f32 v212, v212, v244
ds_bpermute_b32 v242, v239, v204
ds_bpermute_b32 v243, v239, v208
ds_bpermute_b32 v244, v239, v212
s_waitcnt lgkmcnt(0)
v_max_f32 v204, v204, v242
v_max_f32 v208, v208, v243
v_max_f32 v212, v212, v244
v_sub_f32 v204, 0, v204
v_mov_b32 v205, v204
v_mov_b32 v206, v204
v_mov_b32 v207, v204
v_sub_f32 v208, 0, v208
v_mov_b32 v209, v208
v_mov_b32 v210, v208
v_mov_b32 v211, v208
v_sub_f32 v212, 0, v212
v_mov_b32 v213, v212
v_mov_b32 v214, v212
v_mov_b32 v215, v212
v_readfirstlane_b32 s75, v247
v_add_f32 v144, v144, v204
v_add_f32 v145, v145, v204
v_add_f32 v146, v146, v204
v_add_f32 v147, v147, v204
v_add_f32 v148, v148, v204
v_add_f32 v149, v149, v204
v_add_f32 v150, v150, v204
v_add_f32 v151, v151, v204
v_add_f32 v152, v152, v208
v_add_f32 v153, v153, v208
v_add_f32 v154, v154, v208
v_add_f32 v155, v155, v208
v_add_f32 v156, v156, v208
v_add_f32 v157, v157, v208
v_add_f32 v158, v158, v208
v_add_f32 v159, v159, v208
v_add_f32 v160, v160, v212
v_add_f32 v161, v161, v212
v_add_f32 v162, v162, v212
v_add_f32 v163, v163, v212
v_add_f32 v164, v164, v212
v_add_f32 v165, v165, v212
v_add_f32 v166, v166, v212
v_add_f32 v167, v167, v212
v_exp_f32 v144, v144
v_exp_f32 v145, v145
v_exp_f32 v146, v146
v_exp_f32 v147, v147
v_exp_f32 v148, v148
v_exp_f32 v149, v149
v_exp_f32 v150, v150
v_exp_f32 v151, v151
v_exp_f32 v152, v152
v_exp_f32 v153, v153
v_exp_f32 v154, v154
v_exp_f32 v155, v155
s_and_b32 s69, s2, 7
s_lshr_b32 s70, s2, 3
s_lshr_b32 s73, s69, 1
s_and_b32 s69, s69, 1
s_lshl_b32 s69, s69, 2
s_lshr_b32 s71, s70, 3
s_add_u32 s72, s69, s71
s_and_b32 s74, s70, 7
s_mul_i32 s69, s72, 32
s_lshl_b32 s70, s73, 3
s_add_u32 s69, s69, s70
s_mul_i32 s69, s69, 36864
s_add_u32 s24, s18, s69
s_addc_u32 s25, s19, 0
s_mov_b32 s26, 294912
s_mov_b32 s27, 0x20000
s_add_u32 s44, s18, 16777216
s_addc_u32 s45, s19, 0
s_mov_b32 s46, 8192
s_mov_b32 s47, 0x20000
v_lshlrev_b32 v245, 4, v236
v_lshlrev_b32 v246, 3, v236
v_and_b32 v246, 0xff, v246
s_lshl_b32 s69, s72, 2
s_add_u32 s69, s69, s73
s_lshl_b32 s69, s69, 8
v_add_u32 v246, s69, v246
s_add_u32 s69, s3, 0
s_and_b32 s69, s69, 3
s_lshl_b32 s85, s69, 12
s_lshl_b32 s69, s69, 10
s_lshl_b32 s70, s3, 13
s_add_u32 s76, s69, s70
s_add_u32 s77, s76, 4096
s_add_u32 s69, s3, 1
s_and_b32 s69, s69, 3
s_lshl_b32 s86, s69, 12
s_lshl_b32 s69, s69, 10
s_lshl_b32 s70, s3, 13
s_add_u32 s78, s69, s70
s_add_u32 s79, s78, 4096
s_add_u32 s69, s3, 2
s_and_b32 s69, s69, 3
s_lshl_b32 s87, s69, 12
s_lshl_b32 s69, s69, 10
s_lshl_b32 s70, s3, 13
s_add_u32 s80, s69, s70
s_add_u32 s81, s80, 4096
s_add_u32 s69, s3, 3
s_and_b32 s69, s69, 3
s_lshl_b32 s88, s69, 12
s_lshl_b32 s69, s69, 10
s_lshl_b32 s70, s3, 13
s_add_u32 s82, s69, s70
s_add_u32 s83, s82, 4096
s_lshl_b32 s69, s3, 10
s_add_u32 s84, s69, 32768
v_lshrrev_b32 v244, 5, v236
v_lshlrev_b32 v244, 10, v244
v_bfe_u32 v243, v236, 2, 3
v_lshl_add_u32 v244, v243, 7, v244
v_and_b32 v242, 3, v236
v_lshl_add_u32 v244, v242, 3, v244
v_lshrrev_b32 v243, 1, v243
v_xor_b32 v242, 0, v243
v_lshl_add_u32 v247, v242, 5, v244
v_xor_b32 v242, 1, v243
v_lshl_add_u32 v248, v242, 5, v244
v_xor_b32 v242, 2, v243
v_lshl_add_u32 v249, v242, 5, v244
v_xor_b32 v242, 3, v243
v_lshl_add_u32 v250, v242, 5, v244
s_lshl_b32 s69, s72, 3
s_add_u32 s69, s69, s74
s_lshl_b32 s69, s69, 2
s_add_u32 s89, s69, s3
s_lshl_b32 s69, s89, 2
s_mul_i32 s69, s69, 9216
s_add_u32 s69, s69, 33554432
s_add_u32 s20, s18, s69
s_addc_u32 s21, s19, 0
s_mov_b32 s22, 36864
s_mov_b32 s23, 0x20000
s_mul_i32 s69, s50, 36864
s_add_u32 s36, s18, s69
s_addc_u32 s37, s19, 0
s_mov_b32 s38, 36864
s_mov_b32 s39, 0x20000
s_waitcnt lgkmcnt(4)
v_mfma_f32_16x16x32_bf16 v[168:171], a[0:3], v[96:99], v[204:207]
v_exp_f32 v156, v156
v_mfma_f32_16x16x32_bf16 v[168:171], a[4:7], v[100:103], v[168:171]
v_exp_f32 v157, v157
v_mfma_f32_16x16x32_bf16 v[168:171], a[8:11], v[104:107], v[168:171]
v_exp_f32 v158, v158
v_mfma_f32_16x16x32_bf16 v[168:171], a[12:15], v[108:111], v[168:171]
v_exp_f32 v159, v159
v_mfma_f32_16x16x32_bf16 v[172:175], a[16:19], v[96:99], v[204:207]
v_exp_f32 v160, v160
v_mfma_f32_16x16x32_bf16 v[172:175], a[20:23], v[100:103], v[172:175]
v_exp_f32 v161, v161
v_mfma_f32_16x16x32_bf16 v[172:175], a[24:27], v[104:107], v[172:175]
v_exp_f32 v162, v162
v_mfma_f32_16x16x32_bf16 v[172:175], a[28:31], v[108:111], v[172:175]
v_exp_f32 v163, v163
v_mfma_f32_16x16x32_bf16 v[176:179], a[0:3], v[112:115], v[208:211]
v_exp_f32 v164, v164
v_mfma_f32_16x16x32_bf16 v[176:179], a[4:7], v[116:119], v[176:179]
v_exp_f32 v165, v165
v_mfma_f32_16x16x32_bf16 v[176:179], a[8:11], v[120:123], v[176:179]
v_exp_f32 v166, v166
v_mfma_f32_16x16x32_bf16 v[176:179], a[12:15], v[124:127], v[176:179]
v_exp_f32 v167, v167
v_mfma_f32_16x16x32_bf16 v[180:183], a[16:19], v[112:115], v[208:211]
v_cvt_pk_bf16_f32 v192, v144, v145
v_cvt_pk_bf16_f32 v193, v146, v147
v_mfma_f32_16x16x32_bf16 v[180:183], a[20:23], v[116:119], v[180:183]
v_cvt_pk_bf16_f32 v194, v148, v149
v_cvt_pk_bf16_f32 v195, v150, v151
v_mfma_f32_16x16x32_bf16 v[180:183], a[24:27], v[120:123], v[180:183]
v_cvt_pk_bf16_f32 v196, v152, v153
v_cvt_pk_bf16_f32 v197, v154, v155
v_mfma_f32_16x16x32_bf16 v[180:183], a[28:31], v[124:127], v[180:183]
v_cvt_pk_bf16_f32 v198, v156, v157
v_cvt_pk_bf16_f32 v199, v158, v159
v_mfma_f32_16x16x32_bf16 v[184:187], a[0:3], v[128:131], v[212:215]
v_cvt_pk_bf16_f32 v200, v160, v161
v_cvt_pk_bf16_f32 v201, v162, v163
v_mfma_f32_16x16x32_bf16 v[184:187], a[4:7], v[132:135], v[184:187]
v_cvt_pk_bf16_f32 v202, v164, v165
v_cvt_pk_bf16_f32 v203, v166, v167
v_mfma_f32_16x16x32_bf16 v[184:187], a[8:11], v[136:139], v[184:187]
s_add_u32 s51, s51, 17664
s_cmp_eq_u32 s51, s52
v_mfma_f32_16x16x32_bf16 v[184:187], a[12:15], v[140:143], v[184:187]
s_cselect_b32 s51, 0, s51
s_cselect_b32 s52, s53, s52
v_mfma_f32_16x16x32_bf16 v[188:191], a[16:19], v[128:131], v[212:215]
s_cselect_b32 s53, 88320, s53
v_mfma_f32_16x16x32_bf16 v[188:191], a[20:23], v[132:135], v[188:191]
v_add_u32 v232, s51, v234
v_add_u32 v233, s51, v235
v_mfma_f32_16x16x32_bf16 v[188:191], a[24:27], v[136:139], v[188:191]
v_mfma_f32_16x16x32_bf16 v[188:191], a[28:31], v[140:143], v[188:191]
s_waitcnt lgkmcnt(0)
s_barrier
v_mfma_f32_16x16x32_bf16 v[0:3], a[32:35], v[192:195], 0
ds_read_b128 a[0:3], v232 offset:0
ds_read_b128 a[4:7], v232 offset:256
v_mfma_f32_16x16x32_bf16 v[32:35], a[32:35], v[196:199], 0
ds_read_b128 a[8:11], v232 offset:512
ds_read_b128 a[12:15], v232 offset:768
v_mfma_f32_16x16x32_bf16 v[64:67], a[32:35], v[200:203], 0
ds_read_b64_tr_b16 a[32:33], v233 offset:0
ds_read_b64_tr_b16 a[34:35], v233 offset:4224
v_mfma_f32_16x16x32_bf16 v[4:7], a[36:39], v[192:195], 0
ds_read_b128 a[16:19], v232 offset:4224
ds_read_b128 a[20:23], v232 offset:4480
v_mfma_f32_16x16x32_bf16 v[36:39], a[36:39], v[196:199], 0
ds_read_b128 a[24:27], v232 offset:4736
ds_read_b128 a[28:31], v232 offset:4992
v_mfma_f32_16x16x32_bf16 v[68:71], a[36:39], v[200:203], 0
ds_read_b64_tr_b16 a[36:37], v233 offset:32
ds_read_b64_tr_b16 a[38:39], v233 offset:4256
v_mfma_f32_16x16x32_bf16 v[8:11], a[40:43], v[192:195], 0
v_exp_f32 v168, v168
v_mfma_f32_16x16x32_bf16 v[40:43], a[40:43], v[196:199], 0
v_exp_f32 v169, v169
v_mfma_f32_16x16x32_bf16 v[72:75], a[40:43], v[200:203], 0
ds_read_b64_tr_b16 a[40:41], v233 offset:256
ds_read_b64_tr_b16 a[42:43], v233 offset:4480
v_mfma_f32_16x16x32_bf16 v[12:15], a[44:47], v[192:195], 0
v_exp_f32 v170, v170
v_mfma_f32_16x16x32_bf16 v[44:47], a[44:47], v[196:199], 0
v_exp_f32 v171, v171
v_mfma_f32_16x16x32_bf16 v[76:79], a[44:47], v[200:203], 0
ds_read_b64_tr_b16 a[44:45], v233 offset:288
ds_read_b64_tr_b16 a[46:47], v233 offset:4512
v_mfma_f32_16x16x32_bf16 v[16:19], a[48:51], v[192:195], 0
v_exp_f32 v172, v172
v_mfma_f32_16x16x32_bf16 v[48:51], a[48:51], v[196:199], 0
v_exp_f32 v173, v173
v_mfma_f32_16x16x32_bf16 v[80:83], a[48:51], v[200:203], 0
ds_read_b64_tr_b16 a[48:49], v233 offset:512
ds_read_b64_tr_b16 a[50:51], v233 offset:4736
v_mfma_f32_16x16x32_bf16 v[20:23], a[52:55], v[192:195], 0
v_exp_f32 v174, v174
v_mfma_f32_16x16x32_bf16 v[52:55], a[52:55], v[196:199], 0
v_exp_f32 v175, v175
v_mfma_f32_16x16x32_bf16 v[84:87], a[52:55], v[200:203], 0
ds_read_b64_tr_b16 a[52:53], v233 offset:544
ds_read_b64_tr_b16 a[54:55], v233 offset:4768
v_mfma_f32_16x16x32_bf16 v[24:27], a[56:59], v[192:195], 0
v_exp_f32 v176, v176
v_mfma_f32_16x16x32_bf16 v[56:59], a[56:59], v[196:199], 0
v_exp_f32 v177, v177
v_mfma_f32_16x16x32_bf16 v[88:91], a[56:59], v[200:203], 0
ds_read_b64_tr_b16 a[56:57], v233 offset:768
ds_read_b64_tr_b16 a[58:59], v233 offset:4992
v_mfma_f32_16x16x32_bf16 v[28:31], a[60:63], v[192:195], 0
v_exp_f32 v178, v178
v_mfma_f32_16x16x32_bf16 v[60:63], a[60:63], v[196:199], 0
v_exp_f32 v179, v179
v_mfma_f32_16x16x32_bf16 v[92:95], a[60:63], v[200:203], 0
ds_read_b64_tr_b16 a[60:61], v233 offset:800
ds_read_b64_tr_b16 a[62:63], v233 offset:5024
v_mfma_f32_16x16x32_bf16 v[216:219], v[228:231], v[192:195], 0
v_mfma_f32_16x16x32_bf16 v[220:223], v[228:231], v[196:199], 0
v_mfma_f32_16x16x32_bf16 v[224:227], v[228:231], v[200:203], 0
s_mov_b32 s54, 30
.p2align 3
L_loop:
s_waitcnt lgkmcnt(4)
v_mfma_f32_16x16x32_bf16 v[144:147], a[0:3], v[96:99], v[204:207]
v_exp_f32 v180, v180
v_mfma_f32_16x16x32_bf16 v[144:147], a[4:7], v[100:103], v[144:147]
v_exp_f32 v181, v181
v_mfma_f32_16x16x32_bf16 v[144:147], a[8:11], v[104:107], v[144:147]
v_exp_f32 v182, v182
v_mfma_f32_16x16x32_bf16 v[144:147], a[12:15], v[108:111], v[144:147]
v_exp_f32 v183, v183
v_mfma_f32_16x16x32_bf16 v[148:151], a[16:19], v[96:99], v[204:207]
v_exp_f32 v184, v184
v_mfma_f32_16x16x32_bf16 v[148:151], a[20:23], v[100:103], v[148:151]
v_exp_f32 v185, v185
v_mfma_f32_16x16x32_bf16 v[148:151], a[24:27], v[104:107], v[148:151]
v_exp_f32 v186, v186
v_mfma_f32_16x16x32_bf16 v[148:151], a[28:31], v[108:111], v[148:151]
v_exp_f32 v187, v187
v_mfma_f32_16x16x32_bf16 v[152:155], a[0:3], v[112:115], v[208:211]
v_exp_f32 v188, v188
v_mfma_f32_16x16x32_bf16 v[152:155], a[4:7], v[116:119], v[152:155]
v_exp_f32 v189, v189
v_mfma_f32_16x16x32_bf16 v[152:155], a[8:11], v[120:123], v[152:155]
v_exp_f32 v190, v190
v_mfma_f32_16x16x32_bf16 v[152:155], a[12:15], v[124:127], v[152:155]
v_exp_f32 v191, v191
v_mfma_f32_16x16x32_bf16 v[156:159], a[16:19], v[112:115], v[208:211]
v_cvt_pk_bf16_f32 v192, v168, v169
v_cvt_pk_bf16_f32 v193, v170, v171
v_mfma_f32_16x16x32_bf16 v[156:159], a[20:23], v[116:119], v[156:159]
v_cvt_pk_bf16_f32 v194, v172, v173
v_cvt_pk_bf16_f32 v195, v174, v175
v_mfma_f32_16x16x32_bf16 v[156:159], a[24:27], v[120:123], v[156:159]
v_cvt_pk_bf16_f32 v196, v176, v177
v_cvt_pk_bf16_f32 v197, v178, v179
v_mfma_f32_16x16x32_bf16 v[156:159], a[28:31], v[124:127], v[156:159]
v_cvt_pk_bf16_f32 v198, v180, v181
v_cvt_pk_bf16_f32 v199, v182, v183
v_mfma_f32_16x16x32_bf16 v[160:163], a[0:3], v[128:131], v[212:215]
v_cvt_pk_bf16_f32 v200, v184, v185
v_cvt_pk_bf16_f32 v201, v186, v187
v_mfma_f32_16x16x32_bf16 v[160:163], a[4:7], v[132:135], v[160:163]
v_cvt_pk_bf16_f32 v202, v188, v189
v_cvt_pk_bf16_f32 v203, v190, v191
v_mfma_f32_16x16x32_bf16 v[160:163], a[8:11], v[136:139], v[160:163]
s_add_u32 s51, s51, 17664
s_cmp_eq_u32 s51, s52
v_mfma_f32_16x16x32_bf16 v[160:163], a[12:15], v[140:143], v[160:163]
s_cselect_b32 s51, 0, s51
s_cselect_b32 s52, s53, s52
v_mfma_f32_16x16x32_bf16 v[164:167], a[16:19], v[128:131], v[212:215]
s_cselect_b32 s53, 88320, s53
v_mfma_f32_16x16x32_bf16 v[164:167], a[20:23], v[132:135], v[164:167]
v_add_u32 v232, s51, v234
v_add_u32 v233, s51, v235
v_mfma_f32_16x16x32_bf16 v[164:167], a[24:27], v[136:139], v[164:167]
v_mfma_f32_16x16x32_bf16 v[164:167], a[28:31], v[140:143], v[164:167]
s_waitcnt lgkmcnt(0)
s_barrier
v_mfma_f32_16x16x32_bf16 v[0:3], a[32:35], v[192:195], v[0:3]
ds_read_b128 a[0:3], v232 offset:0
ds_read_b128 a[4:7], v232 offset:256
v_mfma_f32_16x16x32_bf16 v[32:35], a[32:35], v[196:199], v[32:35]
ds_read_b128 a[8:11], v232 offset:512
ds_read_b128 a[12:15], v232 offset:768
v_mfma_f32_16x16x32_bf16 v[64:67], a[32:35], v[200:203], v[64:67]
ds_read_b64_tr_b16 a[32:33], v233 offset:0
ds_read_b64_tr_b16 a[34:35], v233 offset:4224
v_mfma_f32_16x16x32_bf16 v[4:7], a[36:39], v[192:195], v[4:7]
ds_read_b128 a[16:19], v232 offset:4224
ds_read_b128 a[20:23], v232 offset:4480
v_mfma_f32_16x16x32_bf16 v[36:39], a[36:39], v[196:199], v[36:39]
ds_read_b128 a[24:27], v232 offset:4736
ds_read_b128 a[28:31], v232 offset:4992
v_mfma_f32_16x16x32_bf16 v[68:71], a[36:39], v[200:203], v[68:71]
ds_read_b64_tr_b16 a[36:37], v233 offset:32
ds_read_b64_tr_b16 a[38:39], v233 offset:4256
v_mfma_f32_16x16x32_bf16 v[8:11], a[40:43], v[192:195], v[8:11]
v_exp_f32 v144, v144
v_mfma_f32_16x16x32_bf16 v[40:43], a[40:43], v[196:199], v[40:43]
v_exp_f32 v145, v145
v_mfma_f32_16x16x32_bf16 v[72:75], a[40:43], v[200:203], v[72:75]
ds_read_b64_tr_b16 a[40:41], v233 offset:256
ds_read_b64_tr_b16 a[42:43], v233 offset:4480
v_mfma_f32_16x16x32_bf16 v[12:15], a[44:47], v[192:195], v[12:15]
v_exp_f32 v146, v146
v_mfma_f32_16x16x32_bf16 v[44:47], a[44:47], v[196:199], v[44:47]
v_exp_f32 v147, v147
v_mfma_f32_16x16x32_bf16 v[76:79], a[44:47], v[200:203], v[76:79]
ds_read_b64_tr_b16 a[44:45], v233 offset:288
ds_read_b64_tr_b16 a[46:47], v233 offset:4512
v_mfma_f32_16x16x32_bf16 v[16:19], a[48:51], v[192:195], v[16:19]
v_exp_f32 v148, v148
v_mfma_f32_16x16x32_bf16 v[48:51], a[48:51], v[196:199], v[48:51]
v_exp_f32 v149, v149
v_mfma_f32_16x16x32_bf16 v[80:83], a[48:51], v[200:203], v[80:83]
ds_read_b64_tr_b16 a[48:49], v233 offset:512
ds_read_b64_tr_b16 a[50:51], v233 offset:4736
v_mfma_f32_16x16x32_bf16 v[20:23], a[52:55], v[192:195], v[20:23]
v_exp_f32 v150, v150
v_mfma_f32_16x16x32_bf16 v[52:55], a[52:55], v[196:199], v[52:55]
v_exp_f32 v151, v151
v_mfma_f32_16x16x32_bf16 v[84:87], a[52:55], v[200:203], v[84:87]
ds_read_b64_tr_b16 a[52:53], v233 offset:544
ds_read_b64_tr_b16 a[54:55], v233 offset:4768
v_mfma_f32_16x16x32_bf16 v[24:27], a[56:59], v[192:195], v[24:27]
v_exp_f32 v152, v152
v_mfma_f32_16x16x32_bf16 v[56:59], a[56:59], v[196:199], v[56:59]
v_exp_f32 v153, v153
v_mfma_f32_16x16x32_bf16 v[88:91], a[56:59], v[200:203], v[88:91]
ds_read_b64_tr_b16 a[56:57], v233 offset:768
ds_read_b64_tr_b16 a[58:59], v233 offset:4992
v_mfma_f32_16x16x32_bf16 v[28:31], a[60:63], v[192:195], v[28:31]
v_exp_f32 v154, v154
v_mfma_f32_16x16x32_bf16 v[60:63], a[60:63], v[196:199], v[60:63]
v_exp_f32 v155, v155
v_mfma_f32_16x16x32_bf16 v[92:95], a[60:63], v[200:203], v[92:95]
ds_read_b64_tr_b16 a[60:61], v233 offset:800
ds_read_b64_tr_b16 a[62:63], v233 offset:5024
v_mfma_f32_16x16x32_bf16 v[216:219], v[228:231], v[192:195], v[216:219]
v_mfma_f32_16x16x32_bf16 v[220:223], v[228:231], v[196:199], v[220:223]
v_mfma_f32_16x16x32_bf16 v[224:227], v[228:231], v[200:203], v[224:227]
s_waitcnt lgkmcnt(4)
v_mfma_f32_16x16x32_bf16 v[168:171], a[0:3], v[96:99], v[204:207]
v_exp_f32 v156, v156
v_mfma_f32_16x16x32_bf16 v[168:171], a[4:7], v[100:103], v[168:171]
v_exp_f32 v157, v157
v_mfma_f32_16x16x32_bf16 v[168:171], a[8:11], v[104:107], v[168:171]
v_exp_f32 v158, v158
v_mfma_f32_16x16x32_bf16 v[168:171], a[12:15], v[108:111], v[168:171]
v_exp_f32 v159, v159
v_mfma_f32_16x16x32_bf16 v[172:175], a[16:19], v[96:99], v[204:207]
v_exp_f32 v160, v160
v_mfma_f32_16x16x32_bf16 v[172:175], a[20:23], v[100:103], v[172:175]
v_exp_f32 v161, v161
v_mfma_f32_16x16x32_bf16 v[172:175], a[24:27], v[104:107], v[172:175]
v_exp_f32 v162, v162
v_mfma_f32_16x16x32_bf16 v[172:175], a[28:31], v[108:111], v[172:175]
v_exp_f32 v163, v163
v_mfma_f32_16x16x32_bf16 v[176:179], a[0:3], v[112:115], v[208:211]
v_exp_f32 v164, v164
v_mfma_f32_16x16x32_bf16 v[176:179], a[4:7], v[116:119], v[176:179]
v_exp_f32 v165, v165
v_mfma_f32_16x16x32_bf16 v[176:179], a[8:11], v[120:123], v[176:179]
v_exp_f32 v166, v166
v_mfma_f32_16x16x32_bf16 v[176:179], a[12:15], v[124:127], v[176:179]
v_exp_f32 v167, v167
v_mfma_f32_16x16x32_bf16 v[180:183], a[16:19], v[112:115], v[208:211]
v_cvt_pk_bf16_f32 v192, v144, v145
v_cvt_pk_bf16_f32 v193, v146, v147
v_mfma_f32_16x16x32_bf16 v[180:183], a[20:23], v[116:119], v[180:183]
v_cvt_pk_bf16_f32 v194, v148, v149
v_cvt_pk_bf16_f32 v195, v150, v151
v_mfma_f32_16x16x32_bf16 v[180:183], a[24:27], v[120:123], v[180:183]
v_cvt_pk_bf16_f32 v196, v152, v153
v_cvt_pk_bf16_f32 v197, v154, v155
v_mfma_f32_16x16x32_bf16 v[180:183], a[28:31], v[124:127], v[180:183]
v_cvt_pk_bf16_f32 v198, v156, v157
v_cvt_pk_bf16_f32 v199, v158, v159
v_mfma_f32_16x16x32_bf16 v[184:187], a[0:3], v[128:131], v[212:215]
v_cvt_pk_bf16_f32 v200, v160, v161
v_cvt_pk_bf16_f32 v201, v162, v163
v_mfma_f32_16x16x32_bf16 v[184:187], a[4:7], v[132:135], v[184:187]
v_cvt_pk_bf16_f32 v202, v164, v165
v_cvt_pk_bf16_f32 v203, v166, v167
v_mfma_f32_16x16x32_bf16 v[184:187], a[8:11], v[136:139], v[184:187]
s_add_u32 s51, s51, 17664
s_cmp_eq_u32 s51, s52
v_mfma_f32_16x16x32_bf16 v[184:187], a[12:15], v[140:143], v[184:187]
s_cselect_b32 s51, 0, s51
s_cselect_b32 s52, s53, s52
v_mfma_f32_16x16x32_bf16 v[188:191], a[16:19], v[128:131], v[212:215]
s_cselect_b32 s53, 88320, s53
v_mfma_f32_16x16x32_bf16 v[188:191], a[20:23], v[132:135], v[188:191]
v_add_u32 v232, s51, v234
v_add_u32 v233, s51, v235
v_mfma_f32_16x16x32_bf16 v[188:191], a[24:27], v[136:139], v[188:191]
v_mfma_f32_16x16x32_bf16 v[188:191], a[28:31], v[140:143], v[188:191]
s_waitcnt lgkmcnt(0)
s_barrier
v_mfma_f32_16x16x32_bf16 v[0:3], a[32:35], v[192:195], v[0:3]
ds_read_b128 a[0:3], v232 offset:0
ds_read_b128 a[4:7], v232 offset:256
v_mfma_f32_16x16x32_bf16 v[32:35], a[32:35], v[196:199], v[32:35]
ds_read_b128 a[8:11], v232 offset:512
ds_read_b128 a[12:15], v232 offset:768
v_mfma_f32_16x16x32_bf16 v[64:67], a[32:35], v[200:203], v[64:67]
ds_read_b64_tr_b16 a[32:33], v233 offset:0
ds_read_b64_tr_b16 a[34:35], v233 offset:4224
v_mfma_f32_16x16x32_bf16 v[4:7], a[36:39], v[192:195], v[4:7]
ds_read_b128 a[16:19], v232 offset:4224
ds_read_b128 a[20:23], v232 offset:4480
v_mfma_f32_16x16x32_bf16 v[36:39], a[36:39], v[196:199], v[36:39]
ds_read_b128 a[24:27], v232 offset:4736
ds_read_b128 a[28:31], v232 offset:4992
v_mfma_f32_16x16x32_bf16 v[68:71], a[36:39], v[200:203], v[68:71]
ds_read_b64_tr_b16 a[36:37], v233 offset:32
ds_read_b64_tr_b16 a[38:39], v233 offset:4256
v_mfma_f32_16x16x32_bf16 v[8:11], a[40:43], v[192:195], v[8:11]
v_exp_f32 v168, v168
v_mfma_f32_16x16x32_bf16 v[40:43], a[40:43], v[196:199], v[40:43]
v_exp_f32 v169, v169
v_mfma_f32_16x16x32_bf16 v[72:75], a[40:43], v[200:203], v[72:75]
ds_read_b64_tr_b16 a[40:41], v233 offset:256
ds_read_b64_tr_b16 a[42:43], v233 offset:4480
v_mfma_f32_16x16x32_bf16 v[12:15], a[44:47], v[192:195], v[12:15]
v_exp_f32 v170, v170
v_mfma_f32_16x16x32_bf16 v[44:47], a[44:47], v[196:199], v[44:47]
v_exp_f32 v171, v171
v_mfma_f32_16x16x32_bf16 v[76:79], a[44:47], v[200:203], v[76:79]
ds_read_b64_tr_b16 a[44:45], v233 offset:288
ds_read_b64_tr_b16 a[46:47], v233 offset:4512
v_mfma_f32_16x16x32_bf16 v[16:19], a[48:51], v[192:195], v[16:19]
v_exp_f32 v172, v172
v_mfma_f32_16x16x32_bf16 v[48:51], a[48:51], v[196:199], v[48:51]
v_exp_f32 v173, v173
v_mfma_f32_16x16x32_bf16 v[80:83], a[48:51], v[200:203], v[80:83]
ds_read_b64_tr_b16 a[48:49], v233 offset:512
ds_read_b64_tr_b16 a[50:51], v233 offset:4736
v_mfma_f32_16x16x32_bf16 v[20:23], a[52:55], v[192:195], v[20:23]
v_exp_f32 v174, v174
v_mfma_f32_16x16x32_bf16 v[52:55], a[52:55], v[196:199], v[52:55]
v_exp_f32 v175, v175
v_mfma_f32_16x16x32_bf16 v[84:87], a[52:55], v[200:203], v[84:87]
ds_read_b64_tr_b16 a[52:53], v233 offset:544
ds_read_b64_tr_b16 a[54:55], v233 offset:4768
v_mfma_f32_16x16x32_bf16 v[24:27], a[56:59], v[192:195], v[24:27]
v_exp_f32 v176, v176
v_mfma_f32_16x16x32_bf16 v[56:59], a[56:59], v[196:199], v[56:59]
v_exp_f32 v177, v177
v_mfma_f32_16x16x32_bf16 v[88:91], a[56:59], v[200:203], v[88:91]
ds_read_b64_tr_b16 a[56:57], v233 offset:768
ds_read_b64_tr_b16 a[58:59], v233 offset:4992
v_mfma_f32_16x16x32_bf16 v[28:31], a[60:63], v[192:195], v[28:31]
v_exp_f32 v178, v178
v_mfma_f32_16x16x32_bf16 v[60:63], a[60:63], v[196:199], v[60:63]
v_exp_f32 v179, v179
v_mfma_f32_16x16x32_bf16 v[92:95], a[60:63], v[200:203], v[92:95]
ds_read_b64_tr_b16 a[60:61], v233 offset:800
ds_read_b64_tr_b16 a[62:63], v233 offset:5024
v_mfma_f32_16x16x32_bf16 v[216:219], v[228:231], v[192:195], v[216:219]
v_mfma_f32_16x16x32_bf16 v[220:223], v[228:231], v[196:199], v[220:223]
v_mfma_f32_16x16x32_bf16 v[224:227], v[228:231], v[200:203], v[224:227]
s_sub_u32 s54, s54, 1
s_cmp_lg_u32 s54, 0
s_cbranch_scc1 L_loop
s_waitcnt lgkmcnt(4)
v_mfma_f32_16x16x32_bf16 v[144:147], a[0:3], v[96:99], v[204:207]
v_exp_f32 v180, v180
v_mfma_f32_16x16x32_bf16 v[144:147], a[4:7], v[100:103], v[144:147]
v_exp_f32 v181, v181
v_mfma_f32_16x16x32_bf16 v[144:147], a[8:11], v[104:107], v[144:147]
v_exp_f32 v182, v182
v_mfma_f32_16x16x32_bf16 v[144:147], a[12:15], v[108:111], v[144:147]
v_exp_f32 v183, v183
v_mfma_f32_16x16x32_bf16 v[148:151], a[16:19], v[96:99], v[204:207]
v_exp_f32 v184, v184
v_mfma_f32_16x16x32_bf16 v[148:151], a[20:23], v[100:103], v[148:151]
v_exp_f32 v185, v185
v_mfma_f32_16x16x32_bf16 v[148:151], a[24:27], v[104:107], v[148:151]
v_exp_f32 v186, v186
v_mfma_f32_16x16x32_bf16 v[148:151], a[28:31], v[108:111], v[148:151]
v_exp_f32 v187, v187
v_mfma_f32_16x16x32_bf16 v[152:155], a[0:3], v[112:115], v[208:211]
v_exp_f32 v188, v188
v_mfma_f32_16x16x32_bf16 v[152:155], a[4:7], v[116:119], v[152:155]
v_exp_f32 v189, v189
v_mfma_f32_16x16x32_bf16 v[152:155], a[8:11], v[120:123], v[152:155]
v_exp_f32 v190, v190
v_mfma_f32_16x16x32_bf16 v[152:155], a[12:15], v[124:127], v[152:155]
v_exp_f32 v191, v191
v_mfma_f32_16x16x32_bf16 v[156:159], a[16:19], v[112:115], v[208:211]
v_cvt_pk_bf16_f32 v192, v168, v169
v_cvt_pk_bf16_f32 v193, v170, v171
v_mfma_f32_16x16x32_bf16 v[156:159], a[20:23], v[116:119], v[156:159]
v_cvt_pk_bf16_f32 v194, v172, v173
v_cvt_pk_bf16_f32 v195, v174, v175
v_mfma_f32_16x16x32_bf16 v[156:159], a[24:27], v[120:123], v[156:159]
v_cvt_pk_bf16_f32 v196, v176, v177
v_cvt_pk_bf16_f32 v197, v178, v179
v_mfma_f32_16x16x32_bf16 v[156:159], a[28:31], v[124:127], v[156:159]
v_cvt_pk_bf16_f32 v198, v180, v181
v_cvt_pk_bf16_f32 v199, v182, v183
v_mfma_f32_16x16x32_bf16 v[160:163], a[0:3], v[128:131], v[212:215]
v_cvt_pk_bf16_f32 v200, v184, v185
v_cvt_pk_bf16_f32 v201, v186, v187
v_mfma_f32_16x16x32_bf16 v[160:163], a[4:7], v[132:135], v[160:163]
v_cvt_pk_bf16_f32 v202, v188, v189
v_cvt_pk_bf16_f32 v203, v190, v191
v_mfma_f32_16x16x32_bf16 v[160:163], a[8:11], v[136:139], v[160:163]
s_add_u32 s51, s51, 17664
s_cmp_eq_u32 s51, s52
v_mfma_f32_16x16x32_bf16 v[160:163], a[12:15], v[140:143], v[160:163]
s_cselect_b32 s51, 0, s51
s_cselect_b32 s52, s53, s52
v_mfma_f32_16x16x32_bf16 v[164:167], a[16:19], v[128:131], v[212:215]
s_cselect_b32 s53, 88320, s53
v_mfma_f32_16x16x32_bf16 v[164:167], a[20:23], v[132:135], v[164:167]
v_add_u32 v232, s51, v234
v_add_u32 v233, s51, v235
v_mfma_f32_16x16x32_bf16 v[164:167], a[24:27], v[136:139], v[164:167]
v_mfma_f32_16x16x32_bf16 v[164:167], a[28:31], v[140:143], v[164:167]
s_waitcnt lgkmcnt(0)
s_barrier
v_mfma_f32_16x16x32_bf16 v[0:3], a[32:35], v[192:195], v[0:3]
ds_read_b128 a[0:3], v232 offset:0
ds_read_b128 a[4:7], v232 offset:256
v_mfma_f32_16x16x32_bf16 v[32:35], a[32:35], v[196:199], v[32:35]
ds_read_b128 a[8:11], v232 offset:512
ds_read_b128 a[12:15], v232 offset:768
v_mfma_f32_16x16x32_bf16 v[64:67], a[32:35], v[200:203], v[64:67]
ds_read_b64_tr_b16 a[32:33], v233 offset:0
ds_read_b64_tr_b16 a[34:35], v233 offset:4224
v_mfma_f32_16x16x32_bf16 v[4:7], a[36:39], v[192:195], v[4:7]
ds_read_b128 a[16:19], v232 offset:4224
ds_read_b128 a[20:23], v232 offset:4480
v_mfma_f32_16x16x32_bf16 v[36:39], a[36:39], v[196:199], v[36:39]
ds_read_b128 a[24:27], v232 offset:4736
ds_read_b128 a[28:31], v232 offset:4992
v_mfma_f32_16x16x32_bf16 v[68:71], a[36:39], v[200:203], v[68:71]
ds_read_b64_tr_b16 a[36:37], v233 offset:32
ds_read_b64_tr_b16 a[38:39], v233 offset:4256
v_mfma_f32_16x16x32_bf16 v[8:11], a[40:43], v[192:195], v[8:11]
v_exp_f32 v144, v144
v_mfma_f32_16x16x32_bf16 v[40:43], a[40:43], v[196:199], v[40:43]
v_exp_f32 v145, v145
v_mfma_f32_16x16x32_bf16 v[72:75], a[40:43], v[200:203], v[72:75]
ds_read_b64_tr_b16 a[40:41], v233 offset:256
ds_read_b64_tr_b16 a[42:43], v233 offset:4480
v_mfma_f32_16x16x32_bf16 v[12:15], a[44:47], v[192:195], v[12:15]
v_exp_f32 v146, v146
v_mfma_f32_16x16x32_bf16 v[44:47], a[44:47], v[196:199], v[44:47]
v_exp_f32 v147, v147
v_mfma_f32_16x16x32_bf16 v[76:79], a[44:47], v[200:203], v[76:79]
ds_read_b64_tr_b16 a[44:45], v233 offset:288
ds_read_b64_tr_b16 a[46:47], v233 offset:4512
v_mfma_f32_16x16x32_bf16 v[16:19], a[48:51], v[192:195], v[16:19]
v_exp_f32 v148, v148
v_mfma_f32_16x16x32_bf16 v[48:51], a[48:51], v[196:199], v[48:51]
v_exp_f32 v149, v149
v_mfma_f32_16x16x32_bf16 v[80:83], a[48:51], v[200:203], v[80:83]
ds_read_b64_tr_b16 a[48:49], v233 offset:512
ds_read_b64_tr_b16 a[50:51], v233 offset:4736
v_mfma_f32_16x16x32_bf16 v[20:23], a[52:55], v[192:195], v[20:23]
v_exp_f32 v150, v150
v_mfma_f32_16x16x32_bf16 v[52:55], a[52:55], v[196:199], v[52:55]
v_exp_f32 v151, v151
v_mfma_f32_16x16x32_bf16 v[84:87], a[52:55], v[200:203], v[84:87]
ds_read_b64_tr_b16 a[52:53], v233 offset:544
ds_read_b64_tr_b16 a[54:55], v233 offset:4768
v_mfma_f32_16x16x32_bf16 v[24:27], a[56:59], v[192:195], v[24:27]
v_exp_f32 v152, v152
v_mfma_f32_16x16x32_bf16 v[56:59], a[56:59], v[196:199], v[56:59]
v_exp_f32 v153, v153
v_mfma_f32_16x16x32_bf16 v[88:91], a[56:59], v[200:203], v[88:91]
ds_read_b64_tr_b16 a[56:57], v233 offset:768
ds_read_b64_tr_b16 a[58:59], v233 offset:4992
v_mfma_f32_16x16x32_bf16 v[28:31], a[60:63], v[192:195], v[28:31]
v_exp_f32 v154, v154
v_mfma_f32_16x16x32_bf16 v[60:63], a[60:63], v[196:199], v[60:63]
v_exp_f32 v155, v155
v_mfma_f32_16x16x32_bf16 v[92:95], a[60:63], v[200:203], v[92:95]
ds_read_b64_tr_b16 a[60:61], v233 offset:800
ds_read_b64_tr_b16 a[62:63], v233 offset:5024
v_mfma_f32_16x16x32_bf16 v[216:219], v[228:231], v[192:195], v[216:219]
v_mfma_f32_16x16x32_bf16 v[220:223], v[228:231], v[196:199], v[220:223]
v_mfma_f32_16x16x32_bf16 v[224:227], v[228:231], v[200:203], v[224:227]
s_waitcnt lgkmcnt(4)
v_mfma_f32_16x16x32_bf16 v[168:171], a[0:3], v[96:99], v[204:207]
v_exp_f32 v156, v156
v_mfma_f32_16x16x32_bf16 v[168:171], a[4:7], v[100:103], v[168:171]
v_exp_f32 v157, v157
v_mfma_f32_16x16x32_bf16 v[168:171], a[8:11], v[104:107], v[168:171]
v_exp_f32 v158, v158
v_mfma_f32_16x16x32_bf16 v[168:171], a[12:15], v[108:111], v[168:171]
v_exp_f32 v159, v159
v_mfma_f32_16x16x32_bf16 v[172:175], a[16:19], v[96:99], v[204:207]
v_exp_f32 v160, v160
v_mfma_f32_16x16x32_bf16 v[172:175], a[20:23], v[100:103], v[172:175]
v_exp_f32 v161, v161
v_mfma_f32_16x16x32_bf16 v[172:175], a[24:27], v[104:107], v[172:175]
v_exp_f32 v162, v162
v_mfma_f32_16x16x32_bf16 v[172:175], a[28:31], v[108:111], v[172:175]
v_exp_f32 v163, v163
v_mfma_f32_16x16x32_bf16 v[176:179], a[0:3], v[112:115], v[208:211]
v_exp_f32 v164, v164
v_mfma_f32_16x16x32_bf16 v[176:179], a[4:7], v[116:119], v[176:179]
v_exp_f32 v165, v165
v_mfma_f32_16x16x32_bf16 v[176:179], a[8:11], v[120:123], v[176:179]
v_exp_f32 v166, v166
v_mfma_f32_16x16x32_bf16 v[176:179], a[12:15], v[124:127], v[176:179]
v_exp_f32 v167, v167
v_mfma_f32_16x16x32_bf16 v[180:183], a[16:19], v[112:115], v[208:211]
v_cvt_pk_bf16_f32 v192, v144, v145
v_cvt_pk_bf16_f32 v193, v146, v147
v_mfma_f32_16x16x32_bf16 v[180:183], a[20:23], v[116:119], v[180:183]
v_cvt_pk_bf16_f32 v194, v148, v149
v_cvt_pk_bf16_f32 v195, v150, v151
v_mfma_f32_16x16x32_bf16 v[180:183], a[24:27], v[120:123], v[180:183]
v_cvt_pk_bf16_f32 v196, v152, v153
v_cvt_pk_bf16_f32 v197, v154, v155
v_mfma_f32_16x16x32_bf16 v[180:183], a[28:31], v[124:127], v[180:183]
v_cvt_pk_bf16_f32 v198, v156, v157
v_cvt_pk_bf16_f32 v199, v158, v159
v_mfma_f32_16x16x32_bf16 v[184:187], a[0:3], v[128:131], v[212:215]
v_cvt_pk_bf16_f32 v200, v160, v161
v_cvt_pk_bf16_f32 v201, v162, v163
v_mfma_f32_16x16x32_bf16 v[184:187], a[4:7], v[132:135], v[184:187]
v_cvt_pk_bf16_f32 v202, v164, v165
v_cvt_pk_bf16_f32 v203, v166, v167
v_mfma_f32_16x16x32_bf16 v[184:187], a[8:11], v[136:139], v[184:187]
s_add_u32 s51, s51, 17664
s_cmp_eq_u32 s51, s52
v_mfma_f32_16x16x32_bf16 v[184:187], a[12:15], v[140:143], v[184:187]
s_cselect_b32 s51, 0, s51
s_cselect_b32 s52, s53, s52
v_mfma_f32_16x16x32_bf16 v[188:191], a[16:19], v[128:131], v[212:215]
s_cselect_b32 s53, 88320, s53
v_mfma_f32_16x16x32_bf16 v[188:191], a[20:23], v[132:135], v[188:191]
v_add_u32 v232, s51, v234
v_add_u32 v233, s51, v235
v_mfma_f32_16x16x32_bf16 v[188:191], a[24:27], v[136:139], v[188:191]
v_mfma_f32_16x16x32_bf16 v[188:191], a[28:31], v[140:143], v[188:191]
s_waitcnt lgkmcnt(0)
s_barrier
v_mfma_f32_16x16x32_bf16 v[0:3], a[32:35], v[192:195], v[0:3]
v_mfma_f32_16x16x32_bf16 v[32:35], a[32:35], v[196:199], v[32:35]
v_mfma_f32_16x16x32_bf16 v[64:67], a[32:35], v[200:203], v[64:67]
ds_read_b64_tr_b16 a[32:33], v233 offset:0
ds_read_b64_tr_b16 a[34:35], v233 offset:4224
v_mfma_f32_16x16x32_bf16 v[4:7], a[36:39], v[192:195], v[4:7]
v_mfma_f32_16x16x32_bf16 v[36:39], a[36:39], v[196:199], v[36:39]
v_mfma_f32_16x16x32_bf16 v[68:71], a[36:39], v[200:203], v[68:71]
ds_read_b64_tr_b16 a[36:37], v233 offset:32
ds_read_b64_tr_b16 a[38:39], v233 offset:4256
v_mfma_f32_16x16x32_bf16 v[8:11], a[40:43], v[192:195], v[8:11]
v_exp_f32 v168, v168
v_mfma_f32_16x16x32_bf16 v[40:43], a[40:43], v[196:199], v[40:43]
v_exp_f32 v169, v169
v_mfma_f32_16x16x32_bf16 v[72:75], a[40:43], v[200:203], v[72:75]
ds_read_b64_tr_b16 a[40:41], v233 offset:256
ds_read_b64_tr_b16 a[42:43], v233 offset:4480
v_mfma_f32_16x16x32_bf16 v[12:15], a[44:47], v[192:195], v[12:15]
v_exp_f32 v170, v170
v_mfma_f32_16x16x32_bf16 v[44:47], a[44:47], v[196:199], v[44:47]
v_exp_f32 v171, v171
v_mfma_f32_16x16x32_bf16 v[76:79], a[44:47], v[200:203], v[76:79]
ds_read_b64_tr_b16 a[44:45], v233 offset:288
ds_read_b64_tr_b16 a[46:47], v233 offset:4512
v_mfma_f32_16x16x32_bf16 v[16:19], a[48:51], v[192:195], v[16:19]
v_exp_f32 v172, v172
v_mfma_f32_16x16x32_bf16 v[48:51], a[48:51], v[196:199], v[48:51]
v_exp_f32 v173, v173
v_mfma_f32_16x16x32_bf16 v[80:83], a[48:51], v[200:203], v[80:83]
ds_read_b64_tr_b16 a[48:49], v233 offset:512
ds_read_b64_tr_b16 a[50:51], v233 offset:4736
v_mfma_f32_16x16x32_bf16 v[20:23], a[52:55], v[192:195], v[20:23]
v_exp_f32 v174, v174
v_mfma_f32_16x16x32_bf16 v[52:55], a[52:55], v[196:199], v[52:55]
v_exp_f32 v175, v175
v_mfma_f32_16x16x32_bf16 v[84:87], a[52:55], v[200:203], v[84:87]
ds_read_b64_tr_b16 a[52:53], v233 offset:544
ds_read_b64_tr_b16 a[54:55], v233 offset:4768
v_mfma_f32_16x16x32_bf16 v[24:27], a[56:59], v[192:195], v[24:27]
v_exp_f32 v176, v176
v_mfma_f32_16x16x32_bf16 v[56:59], a[56:59], v[196:199], v[56:59]
v_exp_f32 v177, v177
v_mfma_f32_16x16x32_bf16 v[88:91], a[56:59], v[200:203], v[88:91]
ds_read_b64_tr_b16 a[56:57], v233 offset:768
ds_read_b64_tr_b16 a[58:59], v233 offset:4992
v_mfma_f32_16x16x32_bf16 v[28:31], a[60:63], v[192:195], v[28:31]
v_exp_f32 v178, v178
v_mfma_f32_16x16x32_bf16 v[60:63], a[60:63], v[196:199], v[60:63]
v_exp_f32 v179, v179
v_mfma_f32_16x16x32_bf16 v[92:95], a[60:63], v[200:203], v[92:95]
ds_read_b64_tr_b16 a[60:61], v233 offset:800
ds_read_b64_tr_b16 a[62:63], v233 offset:5024
v_mfma_f32_16x16x32_bf16 v[216:219], v[228:231], v[192:195], v[216:219]
v_mfma_f32_16x16x32_bf16 v[220:223], v[228:231], v[196:199], v[220:223]
v_mfma_f32_16x16x32_bf16 v[224:227], v[228:231], v[200:203], v[224:227]
v_exp_f32 v180, v180
v_exp_f32 v181, v181
v_exp_f32 v182, v182
v_exp_f32 v183, v183
v_exp_f32 v184, v184
v_exp_f32 v185, v185
v_exp_f32 v186, v186
v_exp_f32 v187, v187
v_exp_f32 v188, v188
v_exp_f32 v189, v189
v_exp_f32 v190, v190
v_exp_f32 v191, v191
s_nop 0
v_cvt_pk_bf16_f32 v192, v168, v169
v_cvt_pk_bf16_f32 v193, v170, v171
v_cvt_pk_bf16_f32 v194, v172, v173
v_cvt_pk_bf16_f32 v195, v174, v175
v_cvt_pk_bf16_f32 v196, v176, v177
v_cvt_pk_bf16_f32 v197, v178, v179
v_cvt_pk_bf16_f32 v198, v180, v181
v_cvt_pk_bf16_f32 v199, v182, v183
v_cvt_pk_bf16_f32 v200, v184, v185
v_cvt_pk_bf16_f32 v201, v186, v187
v_cvt_pk_bf16_f32 v202, v188, v189
v_cvt_pk_bf16_f32 v203, v190, v191
s_nop 1
s_waitcnt lgkmcnt(0)
v_mfma_f32_16x16x32_bf16 v[0:3], a[32:35], v[192:195], v[0:3]
v_mfma_f32_16x16x32_bf16 v[32:35], a[32:35], v[196:199], v[32:35]
v_mfma_f32_16x16x32_bf16 v[64:67], a[32:35], v[200:203], v[64:67]
v_mfma_f32_16x16x32_bf16 v[4:7], a[36:39], v[192:195], v[4:7]
v_mfma_f32_16x16x32_bf16 v[36:39], a[36:39], v[196:199], v[36:39]
v_mfma_f32_16x16x32_bf16 v[68:71], a[36:39], v[200:203], v[68:71]
v_mfma_f32_16x16x32_bf16 v[8:11], a[40:43], v[192:195], v[8:11]
v_mfma_f32_16x16x32_bf16 v[40:43], a[40:43], v[196:199], v[40:43]
v_mfma_f32_16x16x32_bf16 v[72:75], a[40:43], v[200:203], v[72:75]
v_mfma_f32_16x16x32_bf16 v[12:15], a[44:47], v[192:195], v[12:15]
v_mfma_f32_16x16x32_bf16 v[44:47], a[44:47], v[196:199], v[44:47]
v_mfma_f32_16x16x32_bf16 v[76:79], a[44:47], v[200:203], v[76:79]
v_mfma_f32_16x16x32_bf16 v[16:19], a[48:51], v[192:195], v[16:19]
v_mfma_f32_16x16x32_bf16 v[48:51], a[48:51], v[196:199], v[48:51]
v_mfma_f32_16x16x32_bf16 v[80:83], a[48:51], v[200:203], v[80:83]
v_mfma_f32_16x16x32_bf16 v[20:23], a[52:55], v[192:195], v[20:23]
v_mfma_f32_16x16x32_bf16 v[52:55], a[52:55], v[196:199], v[52:55]
v_mfma_f32_16x16x32_bf16 v[84:87], a[52:55], v[200:203], v[84:87]
v_mfma_f32_16x16x32_bf16 v[24:27], a[56:59], v[192:195], v[24:27]
v_mfma_f32_16x16x32_bf16 v[56:59], a[56:59], v[196:199], v[56:59]
v_mfma_f32_16x16x32_bf16 v[88:91], a[56:59], v[200:203], v[88:91]
v_mfma_f32_16x16x32_bf16 v[28:31], a[60:63], v[192:195], v[28:31]
v_mfma_f32_16x16x32_bf16 v[60:63], a[60:63], v[196:199], v[60:63]
v_mfma_f32_16x16x32_bf16 v[92:95], a[60:63], v[200:203], v[92:95]
v_mfma_f32_16x16x32_bf16 v[216:219], v[228:231], v[192:195], v[216:219]
v_mfma_f32_16x16x32_bf16 v[220:223], v[228:231], v[196:199], v[220:223]
v_mfma_f32_16x16x32_bf16 v[224:227], v[228:231], v[200:203], v[224:227]
s_nop 7
s_mov_b32 s69, 0x4b800000
v_cmp_ngt_f32 vcc, s69, v216
v_cmp_ngt_f32 s[96:97], s69, v220
v_cmp_ngt_f32 s[98:99], s69, v224
s_nop 3
s_or_b64 vcc, vcc, s[96:97]
s_or_b64 vcc, vcc, s[98:99]
s_mov_b32 s95, 0
s_cbranch_vccnz L_mark_bad
v_rcp_f32 v238, v216
v_rcp_f32 v240, v220
v_rcp_f32 v242, v224
v_mov_b32 v239, v238
v_mov_b32 v241, v240
v_mov_b32 v243, v242
s_mul_i32 s69, s3, 12288
v_pk_mul_f32 v[0:1], v[0:1], v[238:239]
v_pk_mul_f32 v[2:3], v[2:3], v[238:239]
v_pk_mul_f32 v[4:5], v[4:5], v[238:239]
v_pk_mul_f32 v[6:7], v[6:7], v[238:239]
v_cvt_pk_bf16_f32 v144, v0, v1
v_cvt_pk_bf16_f32 v145, v2, v3
v_cvt_pk_bf16_f32 v146, v4, v5
v_cvt_pk_bf16_f32 v147, v6, v7
s_add_u32 s70, s69, 0
buffer_store_dwordx4 v[144:147], v245, s[36:39], s70 offen sc1
v_pk_mul_f32 v[8:9], v[8:9], v[238:239]
v_pk_mul_f32 v[10:11], v[10:11], v[238:239]
v_pk_mul_f32 v[12:13], v[12:13], v[238:239]
v_pk_mul_f32 v[14:15], v[14:15], v[238:239]
v_cvt_pk_bf16_f32 v148, v8, v9
v_cvt_pk_bf16_f32 v149, v10, v11
v_cvt_pk_bf16_f32 v150, v12, v13
v_cvt_pk_bf16_f32 v151, v14, v15
s_add_u32 s70, s69, 1024
buffer_store_dwordx4 v[148:151], v245, s[36:39], s70 offen sc1
v_pk_mul_f32 v[16:17], v[16:17], v[238:239]
v_pk_mul_f32 v[18:19], v[18:19], v[238:239]
v_pk_mul_f32 v[20:21], v[20:21], v[238:239]
v_pk_mul_f32 v[22:23], v[22:23], v[238:239]
v_cvt_pk_bf16_f32 v152, v16, v17
v_cvt_pk_bf16_f32 v153, v18, v19
v_cvt_pk_bf16_f32 v154, v20, v21
v_cvt_pk_bf16_f32 v155, v22, v23
s_add_u32 s70, s69, 2048
buffer_store_dwordx4 v[152:155], v245, s[36:39], s70 offen sc1
v_pk_mul_f32 v[24:25], v[24:25], v[238:239]
v_pk_mul_f32 v[26:27], v[26:27], v[238:239]
v_pk_mul_f32 v[28:29], v[28:29], v[238:239]
v_pk_mul_f32 v[30:31], v[30:31], v[238:239]
v_cvt_pk_bf16_f32 v156, v24, v25
v_cvt_pk_bf16_f32 v157, v26, v27
v_cvt_pk_bf16_f32 v158, v28, v29
v_cvt_pk_bf16_f32 v159, v30, v31
s_add_u32 s70, s69, 3072
buffer_store_dwordx4 v[156:159], v245, s[36:39], s70 offen sc1
v_pk_mul_f32 v[32:33], v[32:33], v[240:241]
v_pk_mul_f32 v[34:35], v[34:35], v[240:241]
v_pk_mul_f32 v[36:37], v[36:37], v[240:241]
v_pk_mul_f32 v[38:39], v[38:39], v[240:241]
v_cvt_pk_bf16_f32 v160, v32, v33
v_cvt_pk_bf16_f32 v161, v34, v35
v_cvt_pk_bf16_f32 v162, v36, v37
v_cvt_pk_bf16_f32 v163, v38, v39
s_add_u32 s70, s69, 4096
buffer_store_dwordx4 v[160:163], v245, s[36:39], s70 offen sc1
v_pk_mul_f32 v[40:41], v[40:41], v[240:241]
v_pk_mul_f32 v[42:43], v[42:43], v[240:241]
v_pk_mul_f32 v[44:45], v[44:45], v[240:241]
v_pk_mul_f32 v[46:47], v[46:47], v[240:241]
v_cvt_pk_bf16_f32 v164, v40, v41
v_cvt_pk_bf16_f32 v165, v42, v43
v_cvt_pk_bf16_f32 v166, v44, v45
v_cvt_pk_bf16_f32 v167, v46, v47
s_add_u32 s70, s69, 5120
buffer_store_dwordx4 v[164:167], v245, s[36:39], s70 offen sc1
v_pk_mul_f32 v[48:49], v[48:49], v[240:241]
v_pk_mul_f32 v[50:51], v[50:51], v[240:241]
v_pk_mul_f32 v[52:53], v[52:53], v[240:241]
v_pk_mul_f32 v[54:55], v[54:55], v[240:241]
v_cvt_pk_bf16_f32 v168, v48, v49
v_cvt_pk_bf16_f32 v169, v50, v51
v_cvt_pk_bf16_f32 v170, v52, v53
v_cvt_pk_bf16_f32 v171, v54, v55
s_add_u32 s70, s69, 6144
buffer_store_dwordx4 v[168:171], v245, s[36:39], s70 offen sc1
v_pk_mul_f32 v[56:57], v[56:57], v[240:241]
v_pk_mul_f32 v[58:59], v[58:59], v[240:241]
v_pk_mul_f32 v[60:61], v[60:61], v[240:241]
v_pk_mul_f32 v[62:63], v[62:63], v[240:241]
v_cvt_pk_bf16_f32 v172, v56, v57
v_cvt_pk_bf16_f32 v173, v58, v59
v_cvt_pk_bf16_f32 v174, v60, v61
v_cvt_pk_bf16_f32 v175, v62, v63
s_add_u32 s70, s69, 7168
buffer_store_dwordx4 v[172:175], v245, s[36:39], s70 offen sc1
v_pk_mul_f32 v[64:65], v[64:65], v[242:243]
v_pk_mul_f32 v[66:67], v[66:67], v[242:243]
v_pk_mul_f32 v[68:69], v[68:69], v[242:243]
v_pk_mul_f32 v[70:71], v[70:71], v[242:243]
v_cvt_pk_bf16_f32 v176, v64, v65
v_cvt_pk_bf16_f32 v177, v66, v67
v_cvt_pk_bf16_f32 v178, v68, v69
v_cvt_pk_bf16_f32 v179, v70, v71
s_add_u32 s70, s69, 8192
buffer_store_dwordx4 v[176:179], v245, s[36:39], s70 offen sc1
v_pk_mul_f32 v[72:73], v[72:73], v[242:243]
v_pk_mul_f32 v[74:75], v[74:75], v[242:243]
v_pk_mul_f32 v[76:77], v[76:77], v[242:243]
v_pk_mul_f32 v[78:79], v[78:79], v[242:243]
v_cvt_pk_bf16_f32 v180, v72, v73
v_cvt_pk_bf16_f32 v181, v74, v75
v_cvt_pk_bf16_f32 v182, v76, v77
v_cvt_pk_bf16_f32 v183, v78, v79
s_add_u32 s70, s69, 9216
buffer_store_dwordx4 v[180:183], v245, s[36:39], s70 offen sc1
v_pk_mul_f32 v[80:81], v[80:81], v[242:243]
v_pk_mul_f32 v[82:83], v[82:83], v[242:243]
v_pk_mul_f32 v[84:85], v[84:85], v[242:243]
v_pk_mul_f32 v[86:87], v[86:87], v[242:243]
v_cvt_pk_bf16_f32 v184, v80, v81
v_cvt_pk_bf16_f32 v185, v82, v83
v_cvt_pk_bf16_f32 v186, v84, v85
v_cvt_pk_bf16_f32 v187, v86, v87
s_add_u32 s70, s69, 10240
buffer_store_dwordx4 v[184:187], v245, s[36:39], s70 offen sc1
v_pk_mul_f32 v[88:89], v[88:89], v[242:243]
v_pk_mul_f32 v[90:91], v[90:91], v[242:243]
v_pk_mul_f32 v[92:93], v[92:93], v[242:243]
v_pk_mul_f32 v[94:95], v[94:95], v[242:243]
v_cvt_pk_bf16_f32 v188, v88, v89
v_cvt_pk_bf16_f32 v189, v90, v91
v_cvt_pk_bf16_f32 v190, v92, v93
v_cvt_pk_bf16_f32 v191, v94, v95
s_add_u32 s70, s69, 11264
buffer_store_dwordx4 v[188:191], v245, s[36:39], s70 offen sc1
s_branch L_join
L_mark_bad:
s_lshl_b32 s69, s3, 2
s_add_u32 s69, s69, 158976
v_mov_b32 v238, s69
v_mov_b32 v239, 1
ds_write_b32 v238, v239
s_mov_b32 s95, 2
s_waitcnt lgkmcnt(0)
s_branch L_join
L_loader:
v_mov_b32 v2, v237
v_mov_b32 v3, v236
v_lshlrev_b32 v10, 16, v3
s_lshl_b32 s69, s49, 8
v_add_u32 v11, s69, v10
global_load_dword v25, v11, s[10:11]
s_mov_b64 exec, 0xff
buffer_load_dword v23, v10, s[28:31], 0 offen nt
buffer_load_dword v24, v10, s[32:35], 0 offen nt
s_mul_i32 s69, s48, 147456
v_add_u32 v11, s69, v10
s_mov_b64 exec, 7
global_load_dword v26, v11, s[4:5]
s_mov_b64 exec, -1
s_cmp_lg_u32 s2, 0
s_cbranch_scc1 L_no_epoch
s_add_u32 s96, s18, 16842752
s_addc_u32 s97, s19, 0
v_mov_b32 v6, 0
global_load_dword v7, v6, s[96:97] sc1
s_waitcnt vmcnt(0)
v_add_u32 v8, 1, v7
v_mov_b32 v9, 1
s_mov_b64 s[98:99], exec
s_mov_b64 exec, 1
global_store_dword v6, v8, s[96:97] sc1
global_store_dwordx2 v6, v[8:9], s[16:17] sc1
s_mov_b64 exec, s[98:99]
s_waitcnt vmcnt(0)
L_no_epoch:
v_mov_b32 v6, 158976
v_mov_b32 v8, 0
v_mov_b32 v9, 0
v_mov_b32 v10, 0
v_mov_b32 v11, 0
ds_write_b128 v6, v[8:11]
s_and_b32 s69, s2, 7
s_lshr_b32 s70, s2, 3
s_lshr_b32 s73, s69, 1
s_and_b32 s69, s69, 1
s_lshl_b32 s69, s69, 2
s_lshr_b32 s71, s70, 3
s_add_u32 s72, s69, s71
s_and_b32 s74, s70, 7
s_getpc_b64 s[96:97]
L_pc:
s_sub_u32 s96, s96, L_pc-standalone__gqa_block_cached__near_ridge_kernel
s_subb_u32 s97, s97, 0
s_lshr_b32 s69, s2, 3
s_lshl_b32 s69, s69, 4
v_add_u32 v10, s69, v3
s_mov_b32 s70, (L_code_end-standalone__gqa_block_cached__near_ridge_kernel+127)/128
v_cmp_gt_u32 vcc, 16, v3
v_cmp_gt_u32 s[98:99], s70, v10
v_lshlrev_b32 v10, 7, v10
v_mov_b32 v11, s97
s_and_b64 s[98:99], s[98:99], vcc
v_add_co_u32 v10, vcc, s96, v10
s_nop 1
v_addc_co_u32 v11, vcc, 0, v11, vcc
s_mov_b64 exec, s[98:99]
s_cbranch_execz L_cpf_x
global_load_dword v20, v[10:11], off
L_cpf_x:
s_mov_b64 exec, -1
v_mov_b32 v10, 0
s_mul_i32 s69, s50, 36864
s_add_u32 s70, s69, 0
v_writelane_b32 v10, s70, 0
s_add_u32 s70, s69, 32768
v_writelane_b32 v10, s70, 1
s_add_u32 s70, s69, 36860
v_writelane_b32 v10, s70, 2
s_lshl_b32 s69, s72, 2
s_add_u32 s69, s69, s73
s_mul_i32 s69, s69, 294912
s_add_u32 s70, s69, 0
v_writelane_b32 v10, s70, 3
s_add_u32 s70, s69, 32768
v_writelane_b32 v10, s70, 4
s_add_u32 s70, s69, 65536
v_writelane_b32 v10, s70, 5
s_add_u32 s70, s69, 98304
v_writelane_b32 v10, s70, 6
s_add_u32 s70, s69, 131072
v_writelane_b32 v10, s70, 7
s_add_u32 s70, s69, 163840
v_writelane_b32 v10, s70, 8
s_add_u32 s70, s69, 196608
v_writelane_b32 v10, s70, 9
s_add_u32 s70, s69, 229376
v_writelane_b32 v10, s70, 10
s_add_u32 s70, s69, 262144
v_writelane_b32 v10, s70, 11
s_add_u32 s70, s69, 294908
v_writelane_b32 v10, s70, 12
s_mov_b32 s69, 16777216
s_add_u32 s70, s69, 0
v_writelane_b32 v10, s70, 13
s_add_u32 s70, s69, 32768
v_writelane_b32 v10, s70, 14
s_add_u32 s70, s69, 65536
v_writelane_b32 v10, s70, 15
s_add_u32 s70, s69, 98304
v_writelane_b32 v10, s70, 16
s_add_u32 s70, s69, 131072
v_writelane_b32 v10, s70, 17
s_add_u32 s70, s69, 163840
v_writelane_b32 v10, s70, 18
s_add_u32 s70, s69, 196604
v_writelane_b32 v10, s70, 19
s_lshl_b32 s69, s72, 3
s_add_u32 s69, s69, s74
s_mul_i32 s69, s69, 147456
s_add_u32 s69, s69, 33554432
s_add_u32 s70, s69, 0
v_writelane_b32 v10, s70, 20
s_add_u32 s70, s69, 32768
v_writelane_b32 v10, s70, 21
s_add_u32 s70, s69, 65536
v_writelane_b32 v10, s70, 22
s_add_u32 s70, s69, 98304
v_writelane_b32 v10, s70, 23
s_add_u32 s70, s69, 131072
v_writelane_b32 v10, s70, 24
s_add_u32 s70, s69, 147452
v_writelane_b32 v10, s70, 25
s_mov_b64 exec, 0x3ffffff
global_load_dword v21, v10, s[18:19]
s_mov_b64 exec, -1
s_mul_i32 s69, s72, 147456
v_mul_u32_u24 v10, 32768, v3
v_add_u32 v10, s69, v10
v_min_u32 v10, 1179644, v10
s_mov_b64 exec, 0x1f
global_load_dword v22, v10, s[14:15]
s_mov_b64 exec, -1
s_lshl_b32 s69, s73, 20
s_lshl_b32 s70, s74, 7
s_add_u32 s69, s69, s70
s_add_u32 s40, s12, s69
s_addc_u32 s41, s13, 0
s_sub_u32 s42, 0x100000, s70
s_mov_b32 s43, 0x20000
v_lshrrev_b32 v10, 3, v3
v_bfe_u32 v11, v3, 4, 2
v_lshlrev_b32 v11, 1, v11
v_and_b32 v12, 7, v3
v_xor_b32 v12, v12, v11
v_lshlrev_b32 v12, 4, v12
v_lshlrev_b32 v10, 10, v10
v_add_u32 v5, v10, v12
v_mov_b32 v6, 0
global_load_dwordx2 v[8:9], v6, s[16:17] sc1
s_barrier
s_barrier
s_waitcnt vmcnt(0)
s_mov_b32 s71, 0x100000
L_nonce:
v_readfirstlane_b32 s75, v8
v_readfirstlane_b32 s69, v9
s_sub_u32 s71, s71, 1
s_cmp_eq_u32 s71, 0
s_cbranch_scc1 L_nonce_x
s_cmp_lg_u32 s69, 0
s_cbranch_scc1 L_nonce_x
global_load_dwordx2 v[8:9], v6, s[16:17] sc1
s_waitcnt vmcnt(0)
s_branch L_nonce
L_nonce_x:
v_mov_b32 v6, 158992
v_mov_b32 v7, s75
ds_write_b32 v6, v7
s_waitcnt lgkmcnt(0)
s_barrier
s_barrier
s_barrier
s_barrier
s_barrier
s_barrier
s_barrier
s_mov_b32 s58, 0
s_add_u32 m0, s58, 0
s_nop 0
buffer_load_dwordx4 v2, s[28:31], s56 offen offset:0 nt lds
s_add_u32 m0, s58, 32
s_nop 0
buffer_load_dwordx4 v2, s[28:31], s56 offen offset:1024 nt lds
s_add_u32 m0, s58, 64
s_nop 0
buffer_load_dwordx4 v2, s[28:31], s56 offen offset:2048 nt lds
s_add_u32 m0, s58, 96
s_nop 0
buffer_load_dwordx4 v2, s[28:31], s56 offen offset:3072 nt lds
s_add_u32 m0, s58, 4224
s_add_u32 s69, s56, 4096
buffer_load_dwordx4 v2, s[28:31], s69 offen offset:0 nt lds
s_add_u32 m0, s58, 4256
s_nop 0
buffer_load_dwordx4 v2, s[28:31], s69 offen offset:1024 nt lds
s_add_u32 m0, s58, 4288
s_nop 0
buffer_load_dwordx4 v2, s[28:31], s69 offen offset:2048 nt lds
s_add_u32 m0, s58, 4320
s_nop 0
buffer_load_dwordx4 v2, s[28:31], s69 offen offset:3072 nt lds
s_add_u32 s56, s56, 8192
s_and_b32 s56, s56, 0x7ffff
s_barrier
s_mov_b32 s58, 17664
s_add_u32 m0, s58, 0
s_nop 0
buffer_load_dwordx4 v2, s[28:31], s56 offen offset:0 nt lds
s_add_u32 m0, s58, 32
s_nop 0
buffer_load_dwordx4 v2, s[28:31], s56 offen offset:1024 nt lds
s_add_u32 m0, s58, 64
s_nop 0
buffer_load_dwordx4 v2, s[28:31], s56 offen offset:2048 nt lds
s_add_u32 m0, s58, 96
s_nop 0
buffer_load_dwordx4 v2, s[28:31], s56 offen offset:3072 nt lds
s_add_u32 m0, s58, 4224
s_add_u32 s69, s56, 4096
buffer_load_dwordx4 v2, s[28:31], s69 offen offset:0 nt lds
s_add_u32 m0, s58, 4256
s_nop 0
buffer_load_dwordx4 v2, s[28:31], s69 offen offset:1024 nt lds
s_add_u32 m0, s58, 4288
s_nop 0
buffer_load_dwordx4 v2, s[28:31], s69 offen offset:2048 nt lds
s_add_u32 m0, s58, 4320
s_nop 0
buffer_load_dwordx4 v2, s[28:31], s69 offen offset:3072 nt lds
s_add_u32 s56, s56, 8192
s_and_b32 s56, s56, 0x7ffff
s_barrier
s_mov_b32 s58, 17664
s_add_u32 m0, s58, 8448
s_nop 0
buffer_load_dwordx4 v2, s[32:35], s57 offen offset:0 nt lds
s_add_u32 m0, s58, 8480
s_nop 0
buffer_load_dwordx4 v2, s[32:35], s57 offen offset:1024 nt lds
s_add_u32 m0, s58, 8512
s_nop 0
buffer_load_dwordx4 v2, s[32:35], s57 offen offset:2048 nt lds
s_add_u32 m0, s58, 8544
s_nop 0
buffer_load_dwordx4 v2, s[32:35], s57 offen offset:3072 nt lds
s_add_u32 m0, s58, 12672
s_add_u32 s69, s57, 4096
buffer_load_dwordx4 v2, s[32:35], s69 offen offset:0 nt lds
s_add_u32 m0, s58, 12704
s_nop 0
buffer_load_dwordx4 v2, s[32:35], s69 offen offset:1024 nt lds
s_add_u32 m0, s58, 12736
s_nop 0
buffer_load_dwordx4 v2, s[32:35], s69 offen offset:2048 nt lds
s_add_u32 m0, s58, 12768
s_nop 0
buffer_load_dwordx4 v2, s[32:35], s69 offen offset:3072 nt lds
s_add_u32 s57, s57, 8192
s_and_b32 s57, s57, 0x7ffff
s_barrier
s_mov_b32 s58, 35328
s_add_u32 m0, s58, 0
s_nop 0
buffer_load_dwordx4 v2, s[28:31], s56 offen offset:0 nt lds
s_add_u32 m0, s58, 32
s_nop 0
buffer_load_dwordx4 v2, s[28:31], s56 offen offset:1024 nt lds
s_add_u32 m0, s58, 64
s_nop 0
buffer_load_dwordx4 v2, s[28:31], s56 offen offset:2048 nt lds
s_add_u32 m0, s58, 96
s_nop 0
buffer_load_dwordx4 v2, s[28:31], s56 offen offset:3072 nt lds
s_add_u32 m0, s58, 4224
s_add_u32 s69, s56, 4096
buffer_load_dwordx4 v2, s[28:31], s69 offen offset:0 nt lds
s_add_u32 m0, s58, 4256
s_nop 0
buffer_load_dwordx4 v2, s[28:31], s69 offen offset:1024 nt lds
s_add_u32 m0, s58, 4288
s_nop 0
buffer_load_dwordx4 v2, s[28:31], s69 offen offset:2048 nt lds
s_add_u32 m0, s58, 4320
s_nop 0
buffer_load_dwordx4 v2, s[28:31], s69 offen offset:3072 nt lds
s_add_u32 s56, s56, 8192
s_and_b32 s56, s56, 0x7ffff
s_barrier
s_mov_b32 s58, 35328
s_add_u32 m0, s58, 8448
s_nop 0
buffer_load_dwordx4 v2, s[32:35], s57 offen offset:0 nt lds
s_add_u32 m0, s58, 8480
s_nop 0
buffer_load_dwordx4 v2, s[32:35], s57 offen offset:1024 nt lds
s_add_u32 m0, s58, 8512
s_nop 0
buffer_load_dwordx4 v2, s[32:35], s57 offen offset:2048 nt lds
s_add_u32 m0, s58, 8544
s_nop 0
buffer_load_dwordx4 v2, s[32:35], s57 offen offset:3072 nt lds
s_add_u32 m0, s58, 12672
s_add_u32 s69, s57, 4096
buffer_load_dwordx4 v2, s[32:35], s69 offen offset:0 nt lds
s_add_u32 m0, s58, 12704
s_nop 0
buffer_load_dwordx4 v2, s[32:35], s69 offen offset:1024 nt lds
s_add_u32 m0, s58, 12736
s_nop 0
buffer_load_dwordx4 v2, s[32:35], s69 offen offset:2048 nt lds
s_add_u32 m0, s58, 12768
s_nop 0
buffer_load_dwordx4 v2, s[32:35], s69 offen offset:3072 nt lds
s_add_u32 s57, s57, 8192
s_and_b32 s57, s57, 0x7ffff
s_barrier
s_mov_b32 s58, 52992
s_add_u32 m0, s58, 0
s_nop 0
buffer_load_dwordx4 v2, s[28:31], s56 offen offset:0 nt lds
s_add_u32 m0, s58, 32
s_nop 0
buffer_load_dwordx4 v2, s[28:31], s56 offen offset:1024 nt lds
s_add_u32 m0, s58, 64
s_nop 0
buffer_load_dwordx4 v2, s[28:31], s56 offen offset:2048 nt lds
s_add_u32 m0, s58, 96
s_nop 0
buffer_load_dwordx4 v2, s[28:31], s56 offen offset:3072 nt lds
s_add_u32 m0, s58, 4224
s_add_u32 s69, s56, 4096
buffer_load_dwordx4 v2, s[28:31], s69 offen offset:0 nt lds
s_add_u32 m0, s58, 4256
s_nop 0
buffer_load_dwordx4 v2, s[28:31], s69 offen offset:1024 nt lds
s_add_u32 m0, s58, 4288
s_nop 0
buffer_load_dwordx4 v2, s[28:31], s69 offen offset:2048 nt lds
s_add_u32 m0, s58, 4320
s_nop 0
buffer_load_dwordx4 v2, s[28:31], s69 offen offset:3072 nt lds
s_add_u32 s56, s56, 8192
s_and_b32 s56, s56, 0x7ffff
s_barrier
s_mov_b32 s58, 52992
s_add_u32 m0, s58, 8448
s_nop 0
buffer_load_dwordx4 v2, s[32:35], s57 offen offset:0 nt lds
s_add_u32 m0, s58, 8480
s_nop 0
buffer_load_dwordx4 v2, s[32:35], s57 offen offset:1024 nt lds
s_add_u32 m0, s58, 8512
s_nop 0
buffer_load_dwordx4 v2, s[32:35], s57 offen offset:2048 nt lds
s_add_u32 m0, s58, 8544
s_nop 0
buffer_load_dwordx4 v2, s[32:35], s57 offen offset:3072 nt lds
s_add_u32 m0, s58, 12672
s_add_u32 s69, s57, 4096
buffer_load_dwordx4 v2, s[32:35], s69 offen offset:0 nt lds
s_add_u32 m0, s58, 12704
s_nop 0
buffer_load_dwordx4 v2, s[32:35], s69 offen offset:1024 nt lds
s_add_u32 m0, s58, 12736
s_nop 0
buffer_load_dwordx4 v2, s[32:35], s69 offen offset:2048 nt lds
s_add_u32 m0, s58, 12768
s_nop 0
buffer_load_dwordx4 v2, s[32:35], s69 offen offset:3072 nt lds
s_add_u32 s57, s57, 8192
s_and_b32 s57, s57, 0x7ffff
s_barrier
s_mov_b32 s58, 70656
s_add_u32 m0, s58, 0
s_nop 0
buffer_load_dwordx4 v2, s[28:31], s56 offen offset:0 nt lds
s_add_u32 m0, s58, 32
s_nop 0
buffer_load_dwordx4 v2, s[28:31], s56 offen offset:1024 nt lds
s_add_u32 m0, s58, 64
s_nop 0
buffer_load_dwordx4 v2, s[28:31], s56 offen offset:2048 nt lds
s_add_u32 m0, s58, 96
s_nop 0
buffer_load_dwordx4 v2, s[28:31], s56 offen offset:3072 nt lds
s_add_u32 m0, s58, 4224
s_add_u32 s69, s56, 4096
buffer_load_dwordx4 v2, s[28:31], s69 offen offset:0 nt lds
s_add_u32 m0, s58, 4256
s_nop 0
buffer_load_dwordx4 v2, s[28:31], s69 offen offset:1024 nt lds
s_add_u32 m0, s58, 4288
s_nop 0
buffer_load_dwordx4 v2, s[28:31], s69 offen offset:2048 nt lds
s_add_u32 m0, s58, 4320
s_nop 0
buffer_load_dwordx4 v2, s[28:31], s69 offen offset:3072 nt lds
s_add_u32 s56, s56, 8192
s_and_b32 s56, s56, 0x7ffff
s_mov_b32 s58, 70656
s_add_u32 m0, s58, 8448
s_nop 0
buffer_load_dwordx4 v2, s[32:35], s57 offen offset:0 nt lds
s_add_u32 m0, s58, 8480
s_nop 0
buffer_load_dwordx4 v2, s[32:35], s57 offen offset:1024 nt lds
s_add_u32 m0, s58, 8512
s_nop 0
buffer_load_dwordx4 v2, s[32:35], s57 offen offset:2048 nt lds
s_add_u32 m0, s58, 8544
s_nop 0
buffer_load_dwordx4 v2, s[32:35], s57 offen offset:3072 nt lds
s_add_u32 m0, s58, 12672
s_add_u32 s69, s57, 4096
buffer_load_dwordx4 v2, s[32:35], s69 offen offset:0 nt lds
s_add_u32 m0, s58, 12704
s_nop 0
buffer_load_dwordx4 v2, s[32:35], s69 offen offset:1024 nt lds
s_add_u32 m0, s58, 12736
s_nop 0
buffer_load_dwordx4 v2, s[32:35], s69 offen offset:2048 nt lds
s_add_u32 m0, s58, 12768
s_nop 0
buffer_load_dwordx4 v2, s[32:35], s69 offen offset:3072 nt lds
s_add_u32 s57, s57, 8192
s_and_b32 s57, s57, 0x7ffff
s_mov_b32 s58, 88320
s_add_u32 m0, s58, 0
s_nop 0
buffer_load_dwordx4 v2, s[28:31], s56 offen offset:0 nt lds
s_add_u32 m0, s58, 32
s_nop 0
buffer_load_dwordx4 v2, s[28:31], s56 offen offset:1024 nt lds
s_add_u32 m0, s58, 64
s_nop 0
buffer_load_dwordx4 v2, s[28:31], s56 offen offset:2048 nt lds
s_add_u32 m0, s58, 96
s_nop 0
buffer_load_dwordx4 v2, s[28:31], s56 offen offset:3072 nt lds
s_add_u32 m0, s58, 4224
s_add_u32 s69, s56, 4096
buffer_load_dwordx4 v2, s[28:31], s69 offen offset:0 nt lds
s_add_u32 m0, s58, 4256
s_nop 0
buffer_load_dwordx4 v2, s[28:31], s69 offen offset:1024 nt lds
s_add_u32 m0, s58, 4288
s_nop 0
buffer_load_dwordx4 v2, s[28:31], s69 offen offset:2048 nt lds
s_add_u32 m0, s58, 4320
s_nop 0
buffer_load_dwordx4 v2, s[28:31], s69 offen offset:3072 nt lds
s_add_u32 s56, s56, 8192
s_and_b32 s56, s56, 0x7ffff
s_mov_b32 s58, 88320
s_add_u32 m0, s58, 8448
s_nop 0
buffer_load_dwordx4 v2, s[32:35], s57 offen offset:0 nt lds
s_add_u32 m0, s58, 8480
s_nop 0
buffer_load_dwordx4 v2, s[32:35], s57 offen offset:1024 nt lds
s_add_u32 m0, s58, 8512
s_nop 0
buffer_load_dwordx4 v2, s[32:35], s57 offen offset:2048 nt lds
s_add_u32 m0, s58, 8544
s_nop 0
buffer_load_dwordx4 v2, s[32:35], s57 offen offset:3072 nt lds
s_add_u32 m0, s58, 12672
s_add_u32 s69, s57, 4096
buffer_load_dwordx4 v2, s[32:35], s69 offen offset:0 nt lds
s_add_u32 m0, s58, 12704
s_nop 0
buffer_load_dwordx4 v2, s[32:35], s69 offen offset:1024 nt lds
s_add_u32 m0, s58, 12736
s_nop 0
buffer_load_dwordx4 v2, s[32:35], s69 offen offset:2048 nt lds
s_add_u32 m0, s58, 12768
s_nop 0
buffer_load_dwordx4 v2, s[32:35], s69 offen offset:3072 nt lds
s_add_u32 s57, s57, 8192
s_and_b32 s57, s57, 0x7ffff
s_mov_b32 s52, 158976
s_mov_b32 s53, 158976
s_mov_b32 s58, 105984
s_waitcnt vmcnt(63)
s_barrier
s_waitcnt vmcnt(63)
s_barrier
s_waitcnt vmcnt(48)
s_barrier
s_mov_b32 s54, 3
s_mov_b32 s59, 32
s_mov_b32 s61, 88320
s_mov_b32 s60, 0
L_ld_loop:
s_waitcnt vmcnt(32)
s_barrier
s_add_u32 m0, s58, 0
s_nop 0
buffer_load_dwordx4 v2, s[28:31], s56 offen offset:0 nt lds
s_add_u32 m0, s58, 32
s_nop 0
buffer_load_dwordx4 v2, s[28:31], s56 offen offset:1024 nt lds
s_add_u32 m0, s58, 64
s_nop 0
buffer_load_dwordx4 v2, s[28:31], s56 offen offset:2048 nt lds
s_add_u32 m0, s58, 96
s_nop 0
buffer_load_dwordx4 v2, s[28:31], s56 offen offset:3072 nt lds
s_add_u32 m0, s58, 4224
s_add_u32 s69, s56, 4096
buffer_load_dwordx4 v2, s[28:31], s69 offen offset:0 nt lds
s_add_u32 m0, s58, 4256
s_nop 0
buffer_load_dwordx4 v2, s[28:31], s69 offen offset:1024 nt lds
s_add_u32 m0, s58, 4288
s_nop 0
buffer_load_dwordx4 v2, s[28:31], s69 offen offset:2048 nt lds
s_add_u32 m0, s58, 4320
s_nop 0
buffer_load_dwordx4 v2, s[28:31], s69 offen offset:3072 nt lds
s_add_u32 s56, s56, 8192
s_and_b32 s56, s56, 0x7ffff
s_add_u32 m0, s58, 8448
s_nop 0
buffer_load_dwordx4 v2, s[32:35], s57 offen offset:0 nt lds
s_add_u32 m0, s58, 8480
s_nop 0
buffer_load_dwordx4 v2, s[32:35], s57 offen offset:1024 nt lds
s_add_u32 m0, s58, 8512
s_nop 0
buffer_load_dwordx4 v2, s[32:35], s57 offen offset:2048 nt lds
s_add_u32 m0, s58, 8544
s_nop 0
buffer_load_dwordx4 v2, s[32:35], s57 offen offset:3072 nt lds
s_add_u32 m0, s58, 12672
s_add_u32 s69, s57, 4096
buffer_load_dwordx4 v2, s[32:35], s69 offen offset:0 nt lds
s_add_u32 m0, s58, 12704
s_nop 0
buffer_load_dwordx4 v2, s[32:35], s69 offen offset:1024 nt lds
s_add_u32 m0, s58, 12736
s_nop 0
buffer_load_dwordx4 v2, s[32:35], s69 offen offset:2048 nt lds
s_add_u32 m0, s58, 12768
s_nop 0
buffer_load_dwordx4 v2, s[32:35], s69 offen offset:3072 nt lds
s_add_u32 s57, s57, 8192
s_and_b32 s57, s57, 0x7ffff
s_add_u32 s58, s58, 17664
s_cmp_eq_u32 s58, s52
s_cselect_b32 s58, 0, s58
s_cselect_b32 s52, s53, s52
s_cselect_b32 s53, 88320, s53
s_cmp_lt_u32 s54, 20
s_cbranch_scc1 L_ld_nw
s_cmp_eq_u32 s59, 0
s_cbranch_scc1 L_ld_nw
s_add_u32 m0, s61, 0
s_add_u32 s69, s60, 0
buffer_load_dwordx4 v5, s[40:43], s69 offen lds
s_add_u32 m0, s61, 1024
s_add_u32 s69, s60, 8192
buffer_load_dwordx4 v5, s[40:43], s69 offen lds
s_add_u32 s61, s61, 2048
s_add_u32 s60, s60, 16384
s_sub_u32 s59, s59, 1
L_ld_nw:
s_add_u32 s54, s54, 1
s_cmp_le_u32 s54, 60
s_cbranch_scc1 L_ld_loop
s_waitcnt vmcnt(32)
s_barrier
s_add_u32 m0, s58, 8448
s_nop 0
buffer_load_dwordx4 v2, s[32:35], s57 offen offset:0 nt lds
s_add_u32 m0, s58, 8480
s_nop 0
buffer_load_dwordx4 v2, s[32:35], s57 offen offset:1024 nt lds
s_add_u32 m0, s58, 8512
s_nop 0
buffer_load_dwordx4 v2, s[32:35], s57 offen offset:2048 nt lds
s_add_u32 m0, s58, 8544
s_nop 0
buffer_load_dwordx4 v2, s[32:35], s57 offen offset:3072 nt lds
s_add_u32 m0, s58, 12672
s_add_u32 s69, s57, 4096
buffer_load_dwordx4 v2, s[32:35], s69 offen offset:0 nt lds
s_add_u32 m0, s58, 12704
s_nop 0
buffer_load_dwordx4 v2, s[32:35], s69 offen offset:1024 nt lds
s_add_u32 m0, s58, 12736
s_nop 0
buffer_load_dwordx4 v2, s[32:35], s69 offen offset:2048 nt lds
s_add_u32 m0, s58, 12768
s_nop 0
buffer_load_dwordx4 v2, s[32:35], s69 offen offset:3072 nt lds
s_add_u32 s57, s57, 8192
s_and_b32 s57, s57, 0x7ffff
s_mov_b32 m0, 35328
s_mov_b32 s69, 524288
buffer_load_dwordx4 v5, s[40:43], s69 offen lds
s_mov_b32 m0, 36352
s_mov_b32 s69, 532480
buffer_load_dwordx4 v5, s[40:43], s69 offen lds
s_mov_b32 m0, 37376
s_mov_b32 s69, 540672
buffer_load_dwordx4 v5, s[40:43], s69 offen lds
s_mov_b32 m0, 38400
s_mov_b32 s69, 548864
buffer_load_dwordx4 v5, s[40:43], s69 offen lds
s_mov_b32 m0, 39424
s_mov_b32 s69, 557056
buffer_load_dwordx4 v5, s[40:43], s69 offen lds
s_mov_b32 m0, 40448
s_mov_b32 s69, 565248
buffer_load_dwordx4 v5, s[40:43], s69 offen lds
s_mov_b32 m0, 41472
s_mov_b32 s69, 573440
buffer_load_dwordx4 v5, s[40:43], s69 offen lds
s_mov_b32 m0, 42496
s_mov_b32 s69, 581632
buffer_load_dwordx4 v5, s[40:43], s69 offen lds
s_mov_b32 m0, 43520
s_mov_b32 s69, 589824
buffer_load_dwordx4 v5, s[40:43], s69 offen lds
s_mov_b32 m0, 44544
s_mov_b32 s69, 598016
buffer_load_dwordx4 v5, s[40:43], s69 offen lds
s_mov_b32 m0, 45568
s_mov_b32 s69, 606208
buffer_load_dwordx4 v5, s[40:43], s69 offen lds
s_mov_b32 m0, 46592
s_mov_b32 s69, 614400
buffer_load_dwordx4 v5, s[40:43], s69 offen lds
s_mov_b32 m0, 47616
s_mov_b32 s69, 622592
buffer_load_dwordx4 v5, s[40:43], s69 offen lds
s_mov_b32 m0, 48640
s_mov_b32 s69, 630784
buffer_load_dwordx4 v5, s[40:43], s69 offen lds
s_mov_b32 m0, 49664
s_mov_b32 s69, 638976
buffer_load_dwordx4 v5, s[40:43], s69 offen lds
s_mov_b32 m0, 50688
s_mov_b32 s69, 647168
buffer_load_dwordx4 v5, s[40:43], s69 offen lds
s_waitcnt vmcnt(40)
s_barrier
s_mov_b32 m0, 52992
s_mov_b32 s69, 655360
buffer_load_dwordx4 v5, s[40:43], s69 offen lds
s_mov_b32 m0, 54016
s_mov_b32 s69, 663552
buffer_load_dwordx4 v5, s[40:43], s69 offen lds
s_mov_b32 m0, 55040
s_mov_b32 s69, 671744
buffer_load_dwordx4 v5, s[40:43], s69 offen lds
s_mov_b32 m0, 56064
s_mov_b32 s69, 679936
buffer_load_dwordx4 v5, s[40:43], s69 offen lds
s_mov_b32 m0, 57088
s_mov_b32 s69, 688128
buffer_load_dwordx4 v5, s[40:43], s69 offen lds
s_mov_b32 m0, 58112
s_mov_b32 s69, 696320
buffer_load_dwordx4 v5, s[40:43], s69 offen lds
s_mov_b32 m0, 59136
s_mov_b32 s69, 704512
buffer_load_dwordx4 v5, s[40:43], s69 offen lds
s_mov_b32 m0, 60160
s_mov_b32 s69, 712704
buffer_load_dwordx4 v5, s[40:43], s69 offen lds
s_mov_b32 m0, 61184
s_mov_b32 s69, 720896
buffer_load_dwordx4 v5, s[40:43], s69 offen lds
s_mov_b32 m0, 62208
s_mov_b32 s69, 729088
buffer_load_dwordx4 v5, s[40:43], s69 offen lds
s_mov_b32 m0, 63232
s_mov_b32 s69, 737280
buffer_load_dwordx4 v5, s[40:43], s69 offen lds
s_mov_b32 m0, 64256
s_mov_b32 s69, 745472
buffer_load_dwordx4 v5, s[40:43], s69 offen lds
s_mov_b32 m0, 65280
s_mov_b32 s69, 753664
buffer_load_dwordx4 v5, s[40:43], s69 offen lds
s_mov_b32 m0, 66304
s_mov_b32 s69, 761856
buffer_load_dwordx4 v5, s[40:43], s69 offen lds
s_mov_b32 m0, 67328
s_mov_b32 s69, 770048
buffer_load_dwordx4 v5, s[40:43], s69 offen lds
s_mov_b32 m0, 68352
s_mov_b32 s69, 778240
buffer_load_dwordx4 v5, s[40:43], s69 offen lds
s_waitcnt vmcnt(40)
s_barrier
s_mov_b32 m0, 70656
s_mov_b32 s69, 786432
buffer_load_dwordx4 v5, s[40:43], s69 offen lds
s_mov_b32 m0, 71680
s_mov_b32 s69, 794624
buffer_load_dwordx4 v5, s[40:43], s69 offen lds
s_mov_b32 m0, 72704
s_mov_b32 s69, 802816
buffer_load_dwordx4 v5, s[40:43], s69 offen lds
s_mov_b32 m0, 73728
s_mov_b32 s69, 811008
buffer_load_dwordx4 v5, s[40:43], s69 offen lds
s_mov_b32 m0, 74752
s_mov_b32 s69, 819200
buffer_load_dwordx4 v5, s[40:43], s69 offen lds
s_mov_b32 m0, 75776
s_mov_b32 s69, 827392
buffer_load_dwordx4 v5, s[40:43], s69 offen lds
s_mov_b32 m0, 76800
s_mov_b32 s69, 835584
buffer_load_dwordx4 v5, s[40:43], s69 offen lds
s_mov_b32 m0, 77824
s_mov_b32 s69, 843776
buffer_load_dwordx4 v5, s[40:43], s69 offen lds
s_mov_b32 m0, 78848
s_mov_b32 s69, 851968
buffer_load_dwordx4 v5, s[40:43], s69 offen lds
s_mov_b32 m0, 79872
s_mov_b32 s69, 860160
buffer_load_dwordx4 v5, s[40:43], s69 offen lds
s_mov_b32 m0, 80896
s_mov_b32 s69, 868352
buffer_load_dwordx4 v5, s[40:43], s69 offen lds
s_mov_b32 m0, 81920
s_mov_b32 s69, 876544
buffer_load_dwordx4 v5, s[40:43], s69 offen lds
s_mov_b32 m0, 82944
s_mov_b32 s69, 884736
buffer_load_dwordx4 v5, s[40:43], s69 offen lds
s_mov_b32 m0, 83968
s_mov_b32 s69, 892928
buffer_load_dwordx4 v5, s[40:43], s69 offen lds
s_mov_b32 m0, 84992
s_mov_b32 s69, 901120
buffer_load_dwordx4 v5, s[40:43], s69 offen lds
s_mov_b32 m0, 86016
s_mov_b32 s69, 909312
buffer_load_dwordx4 v5, s[40:43], s69 offen lds
s_waitcnt vmcnt(48)
s_barrier
s_mov_b32 m0, 0
s_mov_b32 s69, 917504
buffer_load_dwordx4 v5, s[40:43], s69 offen lds
s_mov_b32 m0, 1024
s_mov_b32 s69, 925696
buffer_load_dwordx4 v5, s[40:43], s69 offen lds
s_mov_b32 m0, 2048
s_mov_b32 s69, 933888
buffer_load_dwordx4 v5, s[40:43], s69 offen lds
s_mov_b32 m0, 3072
s_mov_b32 s69, 942080
buffer_load_dwordx4 v5, s[40:43], s69 offen lds
s_mov_b32 m0, 4096
s_mov_b32 s69, 950272
buffer_load_dwordx4 v5, s[40:43], s69 offen lds
s_mov_b32 m0, 5120
s_mov_b32 s69, 958464
buffer_load_dwordx4 v5, s[40:43], s69 offen lds
s_mov_b32 m0, 6144
s_mov_b32 s69, 966656
buffer_load_dwordx4 v5, s[40:43], s69 offen lds
s_mov_b32 m0, 7168
s_mov_b32 s69, 974848
buffer_load_dwordx4 v5, s[40:43], s69 offen lds
s_mov_b32 m0, 8192
s_mov_b32 s69, 983040
buffer_load_dwordx4 v5, s[40:43], s69 offen lds
s_mov_b32 m0, 9216
s_mov_b32 s69, 991232
buffer_load_dwordx4 v5, s[40:43], s69 offen lds
s_mov_b32 m0, 10240
s_mov_b32 s69, 999424
buffer_load_dwordx4 v5, s[40:43], s69 offen lds
s_mov_b32 m0, 11264
s_mov_b32 s69, 1007616
buffer_load_dwordx4 v5, s[40:43], s69 offen lds
s_mov_b32 m0, 12288
s_mov_b32 s69, 1015808
buffer_load_dwordx4 v5, s[40:43], s69 offen lds
s_mov_b32 m0, 13312
s_mov_b32 s69, 1024000
buffer_load_dwordx4 v5, s[40:43], s69 offen lds
s_mov_b32 m0, 14336
s_mov_b32 s69, 1032192
buffer_load_dwordx4 v5, s[40:43], s69 offen lds
s_mov_b32 m0, 15360
s_mov_b32 s69, 1040384
buffer_load_dwordx4 v5, s[40:43], s69 offen lds
v_mov_b32 v236, v3
s_mul_i32 s69, s72, 32
s_lshl_b32 s70, s73, 3
s_add_u32 s69, s69, s70
s_mul_i32 s69, s69, 36864
s_add_u32 s24, s18, s69
s_addc_u32 s25, s19, 0
s_mov_b32 s26, 294912
s_mov_b32 s27, 0x20000
s_add_u32 s44, s18, 16777216
s_addc_u32 s45, s19, 0
s_mov_b32 s46, 8192
s_mov_b32 s47, 0x20000
v_lshlrev_b32 v245, 4, v236
v_lshlrev_b32 v246, 3, v236
v_and_b32 v246, 0xff, v246
s_lshl_b32 s69, s72, 2
s_add_u32 s69, s69, s73
s_lshl_b32 s69, s69, 8
v_add_u32 v246, s69, v246
s_add_u32 s69, s3, 0
s_and_b32 s69, s69, 3
s_lshl_b32 s85, s69, 12
s_lshl_b32 s69, s69, 10
s_lshl_b32 s70, s3, 13
s_add_u32 s76, s69, s70
s_add_u32 s77, s76, 4096
s_add_u32 s69, s3, 1
s_and_b32 s69, s69, 3
s_lshl_b32 s86, s69, 12
s_lshl_b32 s69, s69, 10
s_lshl_b32 s70, s3, 13
s_add_u32 s78, s69, s70
s_add_u32 s79, s78, 4096
s_add_u32 s69, s3, 2
s_and_b32 s69, s69, 3
s_lshl_b32 s87, s69, 12
s_lshl_b32 s69, s69, 10
s_lshl_b32 s70, s3, 13
s_add_u32 s80, s69, s70
s_add_u32 s81, s80, 4096
s_add_u32 s69, s3, 3
s_and_b32 s69, s69, 3
s_lshl_b32 s88, s69, 12
s_lshl_b32 s69, s69, 10
s_lshl_b32 s70, s3, 13
s_add_u32 s82, s69, s70
s_add_u32 s83, s82, 4096
s_lshl_b32 s69, s3, 10
s_add_u32 s84, s69, 32768
v_lshrrev_b32 v244, 5, v236
v_lshlrev_b32 v244, 10, v244
v_bfe_u32 v243, v236, 2, 3
v_lshl_add_u32 v244, v243, 7, v244
v_and_b32 v242, 3, v236
v_lshl_add_u32 v244, v242, 3, v244
v_lshrrev_b32 v243, 1, v243
v_xor_b32 v242, 0, v243
v_lshl_add_u32 v247, v242, 5, v244
v_xor_b32 v242, 1, v243
v_lshl_add_u32 v248, v242, 5, v244
v_xor_b32 v242, 2, v243
v_lshl_add_u32 v249, v242, 5, v244
v_xor_b32 v242, 3, v243
v_lshl_add_u32 v250, v242, 5, v244
s_lshl_b32 s69, s72, 3
s_add_u32 s69, s69, s74
s_lshl_b32 s69, s69, 2
s_add_u32 s89, s69, s3
s_lshl_b32 s69, s89, 2
s_mul_i32 s69, s69, 9216
s_add_u32 s69, s69, 33554432
s_add_u32 s20, s18, s69
s_addc_u32 s21, s19, 0
s_mov_b32 s22, 36864
s_mov_b32 s23, 0x20000
buffer_load_dwordx2 v[8:9], v246, s[44:47], 0 offen sc1
s_not_b32 s70, s75
s_waitcnt vmcnt(0)
v_cmp_eq_u32 vcc, s75, v8
v_cmp_eq_u32 s[96:97], s70, v9
s_nop 3
s_and_b32 s94, vcc_lo, s96
v_mov_b32 v6, 158988
v_mov_b32 v7, s94
ds_write_b32 v6, v7
s_mov_b32 s95, 1
s_waitcnt lgkmcnt(0)
L_join:
s_mov_b32 s54, 0
s_barrier
L_reinit:
v_mov_b32 v238, 158976
ds_read_b128 v[240:243], v238
s_waitcnt lgkmcnt(0)
v_or3_b32 v240, v240, v241, v242
v_readfirstlane_b32 s94, v243
v_readfirstlane_b32 s69, v240
s_lshr_b32 s70, s94, 1
s_lshr_b32 s71, s94, 2
s_and_b32 s94, s94, s70
s_and_b32 s94, s94, s71
s_cmp_lg_u32 s54, 0
s_cselect_b32 s69, 0, s69
s_cmp_lg_u32 s69, 0
s_cbranch_scc1 L_fallback
s_bitcmp1_b32 s94, 0
s_cbranch_scc1 L_sel0
s_waitcnt vmcnt(0)
s_cmp_lg_u32 s95, 0
s_cbranch_scc1 L_sentp0
s_lshl_b32 s69, s50, 2
s_add_u32 s69, s69, s3
s_lshl_b32 s69, s69, 3
v_mov_b32 v238, s75
v_not_b32 v239, v238
v_mov_b32 v240, 0
s_mov_b64 s[96:97], exec
s_mov_b64 exec, 1
buffer_store_dwordx2 v[238:239], v240, s[44:47], s69 offen sc1
s_mov_b64 exec, s[96:97]
s_mov_b32 s95, 1
L_sentp0:
s_mov_b32 s71, 0x100000
L_poll0:
buffer_load_dwordx2 v[112:113], v246, s[44:47], 0 offen sc1
s_not_b32 s70, s75
s_waitcnt vmcnt(0)
v_cmp_eq_u32 vcc, s75, v112
v_cmp_eq_u32 s[96:97], s70, v113
s_nop 3
s_and_b32 s94, vcc_lo, s96
s_lshr_b32 s70, s94, 1
s_lshr_b32 s69, s94, 2
s_and_b32 s94, s94, s70
s_and_b32 s94, s94, s69
s_sub_u32 s71, s71, 1
s_cmp_eq_u32 s71, 0
s_cbranch_scc1 L_sel0
s_bitcmp1_b32 s94, 0
s_cbranch_scc0 L_poll0
L_sel0:
s_add_u32 s69, s76, 0
buffer_load_dwordx4 a[0:3], v245, s[24:27], s69 offen sc1
s_add_u32 s69, s77, 0
buffer_load_dwordx4 a[4:7], v245, s[24:27], s69 offen sc1
s_add_u32 s69, s78, 0
buffer_load_dwordx4 a[8:11], v245, s[24:27], s69 offen sc1
s_add_u32 s69, s79, 0
buffer_load_dwordx4 a[12:15], v245, s[24:27], s69 offen sc1
s_add_u32 s69, s80, 0
buffer_load_dwordx4 a[16:19], v245, s[24:27], s69 offen sc1
s_add_u32 s69, s81, 0
buffer_load_dwordx4 a[20:23], v245, s[24:27], s69 offen sc1
s_add_u32 s69, s82, 0
buffer_load_dwordx4 a[24:27], v245, s[24:27], s69 offen sc1
s_add_u32 s69, s83, 0
buffer_load_dwordx4 a[28:31], v245, s[24:27], s69 offen sc1
s_add_u32 s69, s84, 0
buffer_load_dwordx4 a[32:35], v245, s[24:27], s69 offen sc1
s_bitcmp1_b32 s94, 4
s_cbranch_scc1 L_sel1
s_waitcnt vmcnt(0)
s_cmp_lg_u32 s95, 0
s_cbranch_scc1 L_sentp1
s_lshl_b32 s69, s50, 2
s_add_u32 s69, s69, s3
s_lshl_b32 s69, s69, 3
v_mov_b32 v238, s75
v_not_b32 v239, v238
v_mov_b32 v240, 0
s_mov_b64 s[96:97], exec
s_mov_b64 exec, 1
buffer_store_dwordx2 v[238:239], v240, s[44:47], s69 offen sc1
s_mov_b64 exec, s[96:97]
s_mov_b32 s95, 1
L_sentp1:
s_mov_b32 s71, 0x100000
L_poll1:
buffer_load_dwordx2 v[112:113], v246, s[44:47], 0 offen sc1
s_not_b32 s70, s75
s_waitcnt vmcnt(0)
v_cmp_eq_u32 vcc, s75, v112
v_cmp_eq_u32 s[96:97], s70, v113
s_nop 3
s_and_b32 s94, vcc_lo, s96
s_lshr_b32 s70, s94, 1
s_lshr_b32 s69, s94, 2
s_and_b32 s94, s94, s70
s_and_b32 s94, s94, s69
s_sub_u32 s71, s71, 1
s_cmp_eq_u32 s71, 0
s_cbranch_scc1 L_sel1
s_bitcmp1_b32 s94, 4
s_cbranch_scc0 L_poll1
L_sel1:
s_add_u32 s69, s76, 36864
buffer_load_dwordx4 a[36:39], v245, s[24:27], s69 offen sc1
s_add_u32 s69, s77, 36864
buffer_load_dwordx4 a[40:43], v245, s[24:27], s69 offen sc1
s_add_u32 s69, s78, 36864
buffer_load_dwordx4 a[44:47], v245, s[24:27], s69 offen sc1
s_add_u32 s69, s79, 36864
buffer_load_dwordx4 a[48:51], v245, s[24:27], s69 offen sc1
s_add_u32 s69, s80, 36864
buffer_load_dwordx4 a[52:55], v245, s[24:27], s69 offen sc1
s_add_u32 s69, s81, 36864
buffer_load_dwordx4 a[56:59], v245, s[24:27], s69 offen sc1
s_add_u32 s69, s82, 36864
buffer_load_dwordx4 a[60:63], v245, s[24:27], s69 offen sc1
s_add_u32 s69, s83, 36864
buffer_load_dwordx4 a[64:67], v245, s[24:27], s69 offen sc1
s_add_u32 s69, s84, 36864
buffer_load_dwordx4 a[68:71], v245, s[24:27], s69 offen sc1
s_bitcmp1_b32 s94, 8
s_cbranch_scc1 L_sel2
s_waitcnt vmcnt(0)
s_cmp_lg_u32 s95, 0
s_cbranch_scc1 L_sentp2
s_lshl_b32 s69, s50, 2
s_add_u32 s69, s69, s3
s_lshl_b32 s69, s69, 3
v_mov_b32 v238, s75
v_not_b32 v239, v238
v_mov_b32 v240, 0
s_mov_b64 s[96:97], exec
s_mov_b64 exec, 1
buffer_store_dwordx2 v[238:239], v240, s[44:47], s69 offen sc1
s_mov_b64 exec, s[96:97]
s_mov_b32 s95, 1
L_sentp2:
s_mov_b32 s71, 0x100000
L_poll2:
buffer_load_dwordx2 v[112:113], v246, s[44:47], 0 offen sc1
s_not_b32 s70, s75
s_waitcnt vmcnt(0)
v_cmp_eq_u32 vcc, s75, v112
v_cmp_eq_u32 s[96:97], s70, v113
s_nop 3
s_and_b32 s94, vcc_lo, s96
s_lshr_b32 s70, s94, 1
s_lshr_b32 s69, s94, 2
s_and_b32 s94, s94, s70
s_and_b32 s94, s94, s69
s_sub_u32 s71, s71, 1
s_cmp_eq_u32 s71, 0
s_cbranch_scc1 L_sel2
s_bitcmp1_b32 s94, 8
s_cbranch_scc0 L_poll2
L_sel2:
s_add_u32 s69, s76, 73728
buffer_load_dwordx4 a[72:75], v245, s[24:27], s69 offen sc1
s_add_u32 s69, s77, 73728
buffer_load_dwordx4 a[76:79], v245, s[24:27], s69 offen sc1
s_add_u32 s69, s78, 73728
buffer_load_dwordx4 a[80:83], v245, s[24:27], s69 offen sc1
s_add_u32 s69, s79, 73728
buffer_load_dwordx4 a[84:87], v245, s[24:27], s69 offen sc1
s_add_u32 s69, s80, 73728
buffer_load_dwordx4 a[88:91], v245, s[24:27], s69 offen sc1
s_add_u32 s69, s81, 73728
buffer_load_dwordx4 a[92:95], v245, s[24:27], s69 offen sc1
s_add_u32 s69, s82, 73728
buffer_load_dwordx4 a[96:99], v245, s[24:27], s69 offen sc1
s_add_u32 s69, s83, 73728
buffer_load_dwordx4 a[100:103], v245, s[24:27], s69 offen sc1
s_add_u32 s69, s84, 73728
buffer_load_dwordx4 a[104:107], v245, s[24:27], s69 offen sc1
s_add_u32 s69, s85, 88320
v_add_u32 v96, s69, v247
v_add_u32 v97, s69, v248
v_add_u32 v98, s69, v249
v_add_u32 v99, s69, v250
s_add_u32 s69, s86, 88320
v_add_u32 v100, s69, v247
v_add_u32 v101, s69, v248
v_add_u32 v102, s69, v249
v_add_u32 v103, s69, v250
s_add_u32 s69, s87, 88320
v_add_u32 v104, s69, v247
v_add_u32 v105, s69, v248
v_add_u32 v106, s69, v249
v_add_u32 v107, s69, v250
s_add_u32 s69, s88, 88320
v_add_u32 v108, s69, v247
v_add_u32 v109, s69, v248
v_add_u32 v110, s69, v249
v_add_u32 v111, s69, v250
ds_read_b64_tr_b16 v[48:49], v96 offset:0
ds_read_b64_tr_b16 v[50:51], v96 offset:2048
ds_read_b64_tr_b16 v[52:53], v97 offset:0
ds_read_b64_tr_b16 v[54:55], v97 offset:2048
ds_read_b64_tr_b16 v[56:57], v98 offset:0
ds_read_b64_tr_b16 v[58:59], v98 offset:2048
ds_read_b64_tr_b16 v[60:61], v99 offset:0
ds_read_b64_tr_b16 v[62:63], v99 offset:2048
ds_read_b64_tr_b16 v[64:65], v100 offset:0
ds_read_b64_tr_b16 v[66:67], v100 offset:2048
ds_read_b64_tr_b16 v[68:69], v101 offset:0
ds_read_b64_tr_b16 v[70:71], v101 offset:2048
ds_read_b64_tr_b16 v[72:73], v102 offset:0
ds_read_b64_tr_b16 v[74:75], v102 offset:2048
ds_read_b64_tr_b16 v[76:77], v103 offset:0
ds_read_b64_tr_b16 v[78:79], v103 offset:2048
s_bitcmp1_b32 s94, 12
s_cbranch_scc1 L_sel3
s_waitcnt vmcnt(0)
s_cmp_lg_u32 s95, 0
s_cbranch_scc1 L_sentp3
s_lshl_b32 s69, s50, 2
s_add_u32 s69, s69, s3
s_lshl_b32 s69, s69, 3
v_mov_b32 v238, s75
v_not_b32 v239, v238
v_mov_b32 v240, 0
s_mov_b64 s[96:97], exec
s_mov_b64 exec, 1
buffer_store_dwordx2 v[238:239], v240, s[44:47], s69 offen sc1
s_mov_b64 exec, s[96:97]
s_mov_b32 s95, 1
L_sentp3:
s_mov_b32 s71, 0x100000
L_poll3:
buffer_load_dwordx2 v[112:113], v246, s[44:47], 0 offen sc1
s_not_b32 s70, s75
s_waitcnt vmcnt(0)
v_cmp_eq_u32 vcc, s75, v112
v_cmp_eq_u32 s[96:97], s70, v113
s_nop 3
s_and_b32 s94, vcc_lo, s96
s_lshr_b32 s70, s94, 1
s_lshr_b32 s69, s94, 2
s_and_b32 s94, s94, s70
s_and_b32 s94, s94, s69
s_sub_u32 s71, s71, 1
s_cmp_eq_u32 s71, 0
s_cbranch_scc1 L_sel3
s_bitcmp1_b32 s94, 12
s_cbranch_scc0 L_poll3
L_sel3:
s_waitcnt vmcnt(18)
s_cmp_lg_u32 s95, 0
s_cbranch_scc1 L_sentm
s_lshl_b32 s69, s50, 2
s_add_u32 s69, s69, s3
s_lshl_b32 s69, s69, 3
v_mov_b32 v238, s75
v_not_b32 v239, v238
v_mov_b32 v240, 0
s_mov_b64 s[96:97], exec
s_mov_b64 exec, 1
buffer_store_dwordx2 v[238:239], v240, s[44:47], s69 offen sc1
s_mov_b64 exec, s[96:97]
s_mov_b32 s95, 1
L_sentm:
s_waitcnt lgkmcnt(8)
v_mfma_f32_16x16x32_bf16 v[0:3], v[48:51], a[0:3], 0
ds_read_b64_tr_b16 v[80:81], v104 offset:0
ds_read_b64_tr_b16 v[82:83], v104 offset:2048
v_mfma_f32_16x16x32_bf16 v[4:7], v[52:55], a[0:3], 0
ds_read_b64_tr_b16 v[84:85], v105 offset:0
ds_read_b64_tr_b16 v[86:87], v105 offset:2048
v_mfma_f32_16x16x32_bf16 v[8:11], v[56:59], a[0:3], 0
ds_read_b64_tr_b16 v[88:89], v106 offset:0
ds_read_b64_tr_b16 v[90:91], v106 offset:2048
v_mfma_f32_16x16x32_bf16 v[12:15], v[60:63], a[0:3], 0
ds_read_b64_tr_b16 v[92:93], v107 offset:0
ds_read_b64_tr_b16 v[94:95], v107 offset:2048
v_mfma_f32_16x16x32_bf16 v[16:19], v[48:51], a[4:7], 0
v_mfma_f32_16x16x32_bf16 v[20:23], v[52:55], a[4:7], 0
v_mfma_f32_16x16x32_bf16 v[24:27], v[56:59], a[4:7], 0
s_add_u32 s69, s76, 110592
buffer_load_dwordx4 a[108:111], v245, s[24:27], s69 offen sc1
v_mfma_f32_16x16x32_bf16 v[28:31], v[60:63], a[4:7], 0
s_add_u32 s69, s77, 110592
buffer_load_dwordx4 a[112:115], v245, s[24:27], s69 offen sc1
v_mfma_f32_16x16x32_bf16 v[32:35], v[48:51], a[32:35], 0
s_add_u32 s69, s78, 110592
buffer_load_dwordx4 a[116:119], v245, s[24:27], s69 offen sc1
v_mfma_f32_16x16x32_bf16 v[36:39], v[52:55], a[32:35], 0
s_add_u32 s69, s79, 110592
buffer_load_dwordx4 a[120:123], v245, s[24:27], s69 offen sc1
v_mfma_f32_16x16x32_bf16 v[40:43], v[56:59], a[32:35], 0
s_add_u32 s69, s80, 110592
buffer_load_dwordx4 a[124:127], v245, s[24:27], s69 offen sc1
v_mfma_f32_16x16x32_bf16 v[44:47], v[60:63], a[32:35], 0
s_waitcnt lgkmcnt(8)
v_mfma_f32_16x16x32_bf16 v[0:3], v[64:67], a[8:11], v[0:3]
ds_read_b64_tr_b16 v[48:49], v108 offset:0
ds_read_b64_tr_b16 v[50:51], v108 offset:2048
v_mfma_f32_16x16x32_bf16 v[4:7], v[68:71], a[8:11], v[4:7]
ds_read_b64_tr_b16 v[52:53], v109 offset:0
ds_read_b64_tr_b16 v[54:55], v109 offset:2048
v_mfma_f32_16x16x32_bf16 v[8:11], v[72:75], a[8:11], v[8:11]
ds_read_b64_tr_b16 v[56:57], v110 offset:0
ds_read_b64_tr_b16 v[58:59], v110 offset:2048
v_mfma_f32_16x16x32_bf16 v[12:15], v[76:79], a[8:11], v[12:15]
ds_read_b64_tr_b16 v[60:61], v111 offset:0
ds_read_b64_tr_b16 v[62:63], v111 offset:2048
v_mfma_f32_16x16x32_bf16 v[16:19], v[64:67], a[12:15], v[16:19]
v_mfma_f32_16x16x32_bf16 v[20:23], v[68:71], a[12:15], v[20:23]
v_mfma_f32_16x16x32_bf16 v[24:27], v[72:75], a[12:15], v[24:27]
s_add_u32 s69, s81, 110592
buffer_load_dwordx4 a[128:131], v245, s[24:27], s69 offen sc1
v_mfma_f32_16x16x32_bf16 v[28:31], v[76:79], a[12:15], v[28:31]
s_add_u32 s69, s82, 110592
buffer_load_dwordx4 a[132:135], v245, s[24:27], s69 offen sc1
s_waitcnt lgkmcnt(8)
v_mfma_f32_16x16x32_bf16 v[0:3], v[80:83], a[16:19], v[0:3]
ds_read_b64_tr_b16 v[64:65], v96 offset:16384
ds_read_b64_tr_b16 v[66:67], v96 offset:18432
v_mfma_f32_16x16x32_bf16 v[4:7], v[84:87], a[16:19], v[4:7]
ds_read_b64_tr_b16 v[68:69], v97 offset:16384
ds_read_b64_tr_b16 v[70:71], v97 offset:18432
v_mfma_f32_16x16x32_bf16 v[8:11], v[88:91], a[16:19], v[8:11]
ds_read_b64_tr_b16 v[72:73], v98 offset:16384
ds_read_b64_tr_b16 v[74:75], v98 offset:18432
v_mfma_f32_16x16x32_bf16 v[12:15], v[92:95], a[16:19], v[12:15]
ds_read_b64_tr_b16 v[76:77], v99 offset:16384
ds_read_b64_tr_b16 v[78:79], v99 offset:18432
v_mfma_f32_16x16x32_bf16 v[16:19], v[80:83], a[20:23], v[16:19]
v_mfma_f32_16x16x32_bf16 v[20:23], v[84:87], a[20:23], v[20:23]
v_mfma_f32_16x16x32_bf16 v[24:27], v[88:91], a[20:23], v[24:27]
s_add_u32 s69, s83, 110592
buffer_load_dwordx4 a[136:139], v245, s[24:27], s69 offen sc1
v_mfma_f32_16x16x32_bf16 v[28:31], v[92:95], a[20:23], v[28:31]
s_add_u32 s69, s84, 110592
buffer_load_dwordx4 a[140:143], v245, s[24:27], s69 offen sc1
s_waitcnt lgkmcnt(8)
v_mfma_f32_16x16x32_bf16 v[0:3], v[48:51], a[24:27], v[0:3]
ds_read_b64_tr_b16 v[80:81], v100 offset:16384
ds_read_b64_tr_b16 v[82:83], v100 offset:18432
v_mfma_f32_16x16x32_bf16 v[4:7], v[52:55], a[24:27], v[4:7]
ds_read_b64_tr_b16 v[84:85], v101 offset:16384
ds_read_b64_tr_b16 v[86:87], v101 offset:18432
v_mfma_f32_16x16x32_bf16 v[8:11], v[56:59], a[24:27], v[8:11]
ds_read_b64_tr_b16 v[88:89], v102 offset:16384
ds_read_b64_tr_b16 v[90:91], v102 offset:18432
v_mfma_f32_16x16x32_bf16 v[12:15], v[60:63], a[24:27], v[12:15]
ds_read_b64_tr_b16 v[92:93], v103 offset:16384
ds_read_b64_tr_b16 v[94:95], v103 offset:18432
v_mfma_f32_16x16x32_bf16 v[16:19], v[48:51], a[28:31], v[16:19]
v_mfma_f32_16x16x32_bf16 v[20:23], v[52:55], a[28:31], v[20:23]
v_mfma_f32_16x16x32_bf16 v[24:27], v[56:59], a[28:31], v[24:27]
v_mfma_f32_16x16x32_bf16 v[28:31], v[60:63], a[28:31], v[28:31]
s_bitcmp1_b32 s94, 16
s_cbranch_scc1 L_sel4
s_waitcnt vmcnt(0)
s_cmp_lg_u32 s95, 0
s_cbranch_scc1 L_sentp4
s_lshl_b32 s69, s50, 2
s_add_u32 s69, s69, s3
s_lshl_b32 s69, s69, 3
v_mov_b32 v238, s75
v_not_b32 v239, v238
v_mov_b32 v240, 0
s_mov_b64 s[96:97], exec
s_mov_b64 exec, 1
buffer_store_dwordx2 v[238:239], v240, s[44:47], s69 offen sc1
s_mov_b64 exec, s[96:97]
s_mov_b32 s95, 1
L_sentp4:
s_mov_b32 s71, 0x100000
L_poll4:
buffer_load_dwordx2 v[112:113], v246, s[44:47], 0 offen sc1
s_not_b32 s70, s75
s_waitcnt vmcnt(0)
v_cmp_eq_u32 vcc, s75, v112
v_cmp_eq_u32 s[96:97], s70, v113
s_nop 3
s_and_b32 s94, vcc_lo, s96
s_lshr_b32 s70, s94, 1
s_lshr_b32 s69, s94, 2
s_and_b32 s94, s94, s70
s_and_b32 s94, s94, s69
s_sub_u32 s71, s71, 1
s_cmp_eq_u32 s71, 0
s_cbranch_scc1 L_sel4
s_bitcmp1_b32 s94, 16
s_cbranch_scc0 L_poll4
L_sel4:
s_waitcnt vmcnt(18)
s_waitcnt lgkmcnt(8)
v_mfma_f32_16x16x32_bf16 v[0:3], v[64:67], a[36:39], v[0:3]
ds_read_b64_tr_b16 v[48:49], v104 offset:16384
ds_read_b64_tr_b16 v[50:51], v104 offset:18432
v_mfma_f32_16x16x32_bf16 v[4:7], v[68:71], a[36:39], v[4:7]
ds_read_b64_tr_b16 v[52:53], v105 offset:16384
ds_read_b64_tr_b16 v[54:55], v105 offset:18432
v_mfma_f32_16x16x32_bf16 v[8:11], v[72:75], a[36:39], v[8:11]
ds_read_b64_tr_b16 v[56:57], v106 offset:16384
ds_read_b64_tr_b16 v[58:59], v106 offset:18432
v_mfma_f32_16x16x32_bf16 v[12:15], v[76:79], a[36:39], v[12:15]
ds_read_b64_tr_b16 v[60:61], v107 offset:16384
ds_read_b64_tr_b16 v[62:63], v107 offset:18432
v_mfma_f32_16x16x32_bf16 v[16:19], v[64:67], a[40:43], v[16:19]
v_mfma_f32_16x16x32_bf16 v[20:23], v[68:71], a[40:43], v[20:23]
v_mfma_f32_16x16x32_bf16 v[24:27], v[72:75], a[40:43], v[24:27]
s_add_u32 s69, s76, 147456
buffer_load_dwordx4 a[0:3], v245, s[24:27], s69 offen sc1
v_mfma_f32_16x16x32_bf16 v[28:31], v[76:79], a[40:43], v[28:31]
s_add_u32 s69, s77, 147456
buffer_load_dwordx4 a[4:7], v245, s[24:27], s69 offen sc1
v_mfma_f32_16x16x32_bf16 v[32:35], v[64:67], a[68:71], v[32:35]
s_add_u32 s69, s78, 147456
buffer_load_dwordx4 a[8:11], v245, s[24:27], s69 offen sc1
v_mfma_f32_16x16x32_bf16 v[36:39], v[68:71], a[68:71], v[36:39]
s_add_u32 s69, s79, 147456
buffer_load_dwordx4 a[12:15], v245, s[24:27], s69 offen sc1
v_mfma_f32_16x16x32_bf16 v[40:43], v[72:75], a[68:71], v[40:43]
s_add_u32 s69, s80, 147456
buffer_load_dwordx4 a[16:19], v245, s[24:27], s69 offen sc1
v_mfma_f32_16x16x32_bf16 v[44:47], v[76:79], a[68:71], v[44:47]
s_waitcnt lgkmcnt(8)
v_mfma_f32_16x16x32_bf16 v[0:3], v[80:83], a[44:47], v[0:3]
ds_read_b64_tr_b16 v[64:65], v108 offset:16384
ds_read_b64_tr_b16 v[66:67], v108 offset:18432
v_mfma_f32_16x16x32_bf16 v[4:7], v[84:87], a[44:47], v[4:7]
ds_read_b64_tr_b16 v[68:69], v109 offset:16384
ds_read_b64_tr_b16 v[70:71], v109 offset:18432
v_mfma_f32_16x16x32_bf16 v[8:11], v[88:91], a[44:47], v[8:11]
ds_read_b64_tr_b16 v[72:73], v110 offset:16384
ds_read_b64_tr_b16 v[74:75], v110 offset:18432
v_mfma_f32_16x16x32_bf16 v[12:15], v[92:95], a[44:47], v[12:15]
ds_read_b64_tr_b16 v[76:77], v111 offset:16384
ds_read_b64_tr_b16 v[78:79], v111 offset:18432
v_mfma_f32_16x16x32_bf16 v[16:19], v[80:83], a[48:51], v[16:19]
v_mfma_f32_16x16x32_bf16 v[20:23], v[84:87], a[48:51], v[20:23]
v_mfma_f32_16x16x32_bf16 v[24:27], v[88:91], a[48:51], v[24:27]
s_add_u32 s69, s81, 147456
buffer_load_dwordx4 a[20:23], v245, s[24:27], s69 offen sc1
v_mfma_f32_16x16x32_bf16 v[28:31], v[92:95], a[48:51], v[28:31]
s_add_u32 s69, s82, 147456
buffer_load_dwordx4 a[24:27], v245, s[24:27], s69 offen sc1
s_waitcnt lgkmcnt(8)
v_mfma_f32_16x16x32_bf16 v[0:3], v[48:51], a[52:55], v[0:3]
ds_read_b64_tr_b16 v[80:81], v96 offset:32768
ds_read_b64_tr_b16 v[82:83], v96 offset:34816
v_mfma_f32_16x16x32_bf16 v[4:7], v[52:55], a[52:55], v[4:7]
ds_read_b64_tr_b16 v[84:85], v97 offset:32768
ds_read_b64_tr_b16 v[86:87], v97 offset:34816
v_mfma_f32_16x16x32_bf16 v[8:11], v[56:59], a[52:55], v[8:11]
ds_read_b64_tr_b16 v[88:89], v98 offset:32768
ds_read_b64_tr_b16 v[90:91], v98 offset:34816
v_mfma_f32_16x16x32_bf16 v[12:15], v[60:63], a[52:55], v[12:15]
ds_read_b64_tr_b16 v[92:93], v99 offset:32768
ds_read_b64_tr_b16 v[94:95], v99 offset:34816
v_mfma_f32_16x16x32_bf16 v[16:19], v[48:51], a[56:59], v[16:19]
v_mfma_f32_16x16x32_bf16 v[20:23], v[52:55], a[56:59], v[20:23]
v_mfma_f32_16x16x32_bf16 v[24:27], v[56:59], a[56:59], v[24:27]
s_add_u32 s69, s83, 147456
buffer_load_dwordx4 a[28:31], v245, s[24:27], s69 offen sc1
v_mfma_f32_16x16x32_bf16 v[28:31], v[60:63], a[56:59], v[28:31]
s_add_u32 s69, s84, 147456
buffer_load_dwordx4 a[32:35], v245, s[24:27], s69 offen sc1
s_waitcnt lgkmcnt(8)
v_mfma_f32_16x16x32_bf16 v[0:3], v[64:67], a[60:63], v[0:3]
ds_read_b64_tr_b16 v[48:49], v100 offset:32768
ds_read_b64_tr_b16 v[50:51], v100 offset:34816
v_mfma_f32_16x16x32_bf16 v[4:7], v[68:71], a[60:63], v[4:7]
ds_read_b64_tr_b16 v[52:53], v101 offset:32768
ds_read_b64_tr_b16 v[54:55], v101 offset:34816
v_mfma_f32_16x16x32_bf16 v[8:11], v[72:75], a[60:63], v[8:11]
ds_read_b64_tr_b16 v[56:57], v102 offset:32768
ds_read_b64_tr_b16 v[58:59], v102 offset:34816
v_mfma_f32_16x16x32_bf16 v[12:15], v[76:79], a[60:63], v[12:15]
ds_read_b64_tr_b16 v[60:61], v103 offset:32768
ds_read_b64_tr_b16 v[62:63], v103 offset:34816
v_mfma_f32_16x16x32_bf16 v[16:19], v[64:67], a[64:67], v[16:19]
v_mfma_f32_16x16x32_bf16 v[20:23], v[68:71], a[64:67], v[20:23]
v_mfma_f32_16x16x32_bf16 v[24:27], v[72:75], a[64:67], v[24:27]
v_mfma_f32_16x16x32_bf16 v[28:31], v[76:79], a[64:67], v[28:31]
s_bitcmp1_b32 s94, 20
s_cbranch_scc1 L_sel5
s_waitcnt vmcnt(0)
s_cmp_lg_u32 s95, 0
s_cbranch_scc1 L_sentp5
s_lshl_b32 s69, s50, 2
s_add_u32 s69, s69, s3
s_lshl_b32 s69, s69, 3
v_mov_b32 v238, s75
v_not_b32 v239, v238
v_mov_b32 v240, 0
s_mov_b64 s[96:97], exec
s_mov_b64 exec, 1
buffer_store_dwordx2 v[238:239], v240, s[44:47], s69 offen sc1
s_mov_b64 exec, s[96:97]
s_mov_b32 s95, 1
L_sentp5:
s_mov_b32 s71, 0x100000
L_poll5:
buffer_load_dwordx2 v[112:113], v246, s[44:47], 0 offen sc1
s_not_b32 s70, s75
s_waitcnt vmcnt(0)
v_cmp_eq_u32 vcc, s75, v112
v_cmp_eq_u32 s[96:97], s70, v113
s_nop 3
s_and_b32 s94, vcc_lo, s96
s_lshr_b32 s70, s94, 1
s_lshr_b32 s69, s94, 2
s_and_b32 s94, s94, s70
s_and_b32 s94, s94, s69
s_sub_u32 s71, s71, 1
s_cmp_eq_u32 s71, 0
s_cbranch_scc1 L_sel5
s_bitcmp1_b32 s94, 20
s_cbranch_scc0 L_poll5
L_sel5:
s_waitcnt vmcnt(18)
s_waitcnt lgkmcnt(8)
v_mfma_f32_16x16x32_bf16 v[0:3], v[80:83], a[72:75], v[0:3]
ds_read_b64_tr_b16 v[64:65], v104 offset:32768
ds_read_b64_tr_b16 v[66:67], v104 offset:34816
v_mfma_f32_16x16x32_bf16 v[4:7], v[84:87], a[72:75], v[4:7]
ds_read_b64_tr_b16 v[68:69], v105 offset:32768
ds_read_b64_tr_b16 v[70:71], v105 offset:34816
v_mfma_f32_16x16x32_bf16 v[8:11], v[88:91], a[72:75], v[8:11]
ds_read_b64_tr_b16 v[72:73], v106 offset:32768
ds_read_b64_tr_b16 v[74:75], v106 offset:34816
v_mfma_f32_16x16x32_bf16 v[12:15], v[92:95], a[72:75], v[12:15]
ds_read_b64_tr_b16 v[76:77], v107 offset:32768
ds_read_b64_tr_b16 v[78:79], v107 offset:34816
v_mfma_f32_16x16x32_bf16 v[16:19], v[80:83], a[76:79], v[16:19]
v_mfma_f32_16x16x32_bf16 v[20:23], v[84:87], a[76:79], v[20:23]
v_mfma_f32_16x16x32_bf16 v[24:27], v[88:91], a[76:79], v[24:27]
s_add_u32 s69, s76, 184320
buffer_load_dwordx4 a[36:39], v245, s[24:27], s69 offen sc1
v_mfma_f32_16x16x32_bf16 v[28:31], v[92:95], a[76:79], v[28:31]
s_add_u32 s69, s77, 184320
buffer_load_dwordx4 a[40:43], v245, s[24:27], s69 offen sc1
v_mfma_f32_16x16x32_bf16 v[32:35], v[80:83], a[104:107], v[32:35]
s_add_u32 s69, s78, 184320
buffer_load_dwordx4 a[44:47], v245, s[24:27], s69 offen sc1
v_mfma_f32_16x16x32_bf16 v[36:39], v[84:87], a[104:107], v[36:39]
s_add_u32 s69, s79, 184320
buffer_load_dwordx4 a[48:51], v245, s[24:27], s69 offen sc1
v_mfma_f32_16x16x32_bf16 v[40:43], v[88:91], a[104:107], v[40:43]
s_add_u32 s69, s80, 184320
buffer_load_dwordx4 a[52:55], v245, s[24:27], s69 offen sc1
v_mfma_f32_16x16x32_bf16 v[44:47], v[92:95], a[104:107], v[44:47]
s_waitcnt lgkmcnt(8)
v_mfma_f32_16x16x32_bf16 v[0:3], v[48:51], a[80:83], v[0:3]
ds_read_b64_tr_b16 v[80:81], v108 offset:32768
ds_read_b64_tr_b16 v[82:83], v108 offset:34816
v_mfma_f32_16x16x32_bf16 v[4:7], v[52:55], a[80:83], v[4:7]
ds_read_b64_tr_b16 v[84:85], v109 offset:32768
ds_read_b64_tr_b16 v[86:87], v109 offset:34816
v_mfma_f32_16x16x32_bf16 v[8:11], v[56:59], a[80:83], v[8:11]
ds_read_b64_tr_b16 v[88:89], v110 offset:32768
ds_read_b64_tr_b16 v[90:91], v110 offset:34816
v_mfma_f32_16x16x32_bf16 v[12:15], v[60:63], a[80:83], v[12:15]
ds_read_b64_tr_b16 v[92:93], v111 offset:32768
ds_read_b64_tr_b16 v[94:95], v111 offset:34816
v_mfma_f32_16x16x32_bf16 v[16:19], v[48:51], a[84:87], v[16:19]
v_mfma_f32_16x16x32_bf16 v[20:23], v[52:55], a[84:87], v[20:23]
v_mfma_f32_16x16x32_bf16 v[24:27], v[56:59], a[84:87], v[24:27]
s_add_u32 s69, s81, 184320
buffer_load_dwordx4 a[56:59], v245, s[24:27], s69 offen sc1
v_mfma_f32_16x16x32_bf16 v[28:31], v[60:63], a[84:87], v[28:31]
s_add_u32 s69, s82, 184320
buffer_load_dwordx4 a[60:63], v245, s[24:27], s69 offen sc1
s_waitcnt lgkmcnt(8)
v_mfma_f32_16x16x32_bf16 v[0:3], v[64:67], a[88:91], v[0:3]
ds_read_b64_tr_b16 v[48:49], v96 offset:49152
ds_read_b64_tr_b16 v[50:51], v96 offset:51200
v_mfma_f32_16x16x32_bf16 v[4:7], v[68:71], a[88:91], v[4:7]
ds_read_b64_tr_b16 v[52:53], v97 offset:49152
ds_read_b64_tr_b16 v[54:55], v97 offset:51200
v_mfma_f32_16x16x32_bf16 v[8:11], v[72:75], a[88:91], v[8:11]
ds_read_b64_tr_b16 v[56:57], v98 offset:49152
ds_read_b64_tr_b16 v[58:59], v98 offset:51200
v_mfma_f32_16x16x32_bf16 v[12:15], v[76:79], a[88:91], v[12:15]
ds_read_b64_tr_b16 v[60:61], v99 offset:49152
ds_read_b64_tr_b16 v[62:63], v99 offset:51200
v_mfma_f32_16x16x32_bf16 v[16:19], v[64:67], a[92:95], v[16:19]
v_add_u32 v96, 4294914304, v96
v_add_u32 v97, 4294914304, v97
v_mfma_f32_16x16x32_bf16 v[20:23], v[68:71], a[92:95], v[20:23]
v_add_u32 v98, 4294914304, v98
v_add_u32 v99, 4294914304, v99
v_mfma_f32_16x16x32_bf16 v[24:27], v[72:75], a[92:95], v[24:27]
s_add_u32 s69, s83, 184320
buffer_load_dwordx4 a[64:67], v245, s[24:27], s69 offen sc1
v_mfma_f32_16x16x32_bf16 v[28:31], v[76:79], a[92:95], v[28:31]
s_add_u32 s69, s84, 184320
buffer_load_dwordx4 a[68:71], v245, s[24:27], s69 offen sc1
s_waitcnt lgkmcnt(8)
v_mfma_f32_16x16x32_bf16 v[0:3], v[80:83], a[96:99], v[0:3]
ds_read_b64_tr_b16 v[64:65], v100 offset:49152
ds_read_b64_tr_b16 v[66:67], v100 offset:51200
v_mfma_f32_16x16x32_bf16 v[4:7], v[84:87], a[96:99], v[4:7]
ds_read_b64_tr_b16 v[68:69], v101 offset:49152
ds_read_b64_tr_b16 v[70:71], v101 offset:51200
v_mfma_f32_16x16x32_bf16 v[8:11], v[88:91], a[96:99], v[8:11]
ds_read_b64_tr_b16 v[72:73], v102 offset:49152
ds_read_b64_tr_b16 v[74:75], v102 offset:51200
v_mfma_f32_16x16x32_bf16 v[12:15], v[92:95], a[96:99], v[12:15]
ds_read_b64_tr_b16 v[76:77], v103 offset:49152
ds_read_b64_tr_b16 v[78:79], v103 offset:51200
v_mfma_f32_16x16x32_bf16 v[16:19], v[80:83], a[100:103], v[16:19]
v_add_u32 v100, 4294914304, v100
v_add_u32 v101, 4294914304, v101
v_mfma_f32_16x16x32_bf16 v[20:23], v[84:87], a[100:103], v[20:23]
v_add_u32 v102, 4294914304, v102
v_add_u32 v103, 4294914304, v103
v_mfma_f32_16x16x32_bf16 v[24:27], v[88:91], a[100:103], v[24:27]
v_mfma_f32_16x16x32_bf16 v[28:31], v[92:95], a[100:103], v[28:31]
s_bitcmp1_b32 s94, 24
s_cbranch_scc1 L_sel6
s_waitcnt vmcnt(0)
s_cmp_lg_u32 s95, 0
s_cbranch_scc1 L_sentp6
s_lshl_b32 s69, s50, 2
s_add_u32 s69, s69, s3
s_lshl_b32 s69, s69, 3
v_mov_b32 v238, s75
v_not_b32 v239, v238
v_mov_b32 v240, 0
s_mov_b64 s[96:97], exec
s_mov_b64 exec, 1
buffer_store_dwordx2 v[238:239], v240, s[44:47], s69 offen sc1
s_mov_b64 exec, s[96:97]
s_mov_b32 s95, 1
L_sentp6:
s_mov_b32 s71, 0x100000
L_poll6:
buffer_load_dwordx2 v[112:113], v246, s[44:47], 0 offen sc1
s_not_b32 s70, s75
s_waitcnt vmcnt(0)
v_cmp_eq_u32 vcc, s75, v112
v_cmp_eq_u32 s[96:97], s70, v113
s_nop 3
s_and_b32 s94, vcc_lo, s96
s_lshr_b32 s70, s94, 1
s_lshr_b32 s69, s94, 2
s_and_b32 s94, s94, s70
s_and_b32 s94, s94, s69
s_sub_u32 s71, s71, 1
s_cmp_eq_u32 s71, 0
s_cbranch_scc1 L_sel6
s_bitcmp1_b32 s94, 24
s_cbranch_scc0 L_poll6
L_sel6:
s_waitcnt vmcnt(18)
s_waitcnt lgkmcnt(8)
v_mfma_f32_16x16x32_bf16 v[0:3], v[48:51], a[108:111], v[0:3]
ds_read_b64_tr_b16 v[80:81], v104 offset:49152
ds_read_b64_tr_b16 v[82:83], v104 offset:51200
v_mfma_f32_16x16x32_bf16 v[4:7], v[52:55], a[108:111], v[4:7]
ds_read_b64_tr_b16 v[84:85], v105 offset:49152
ds_read_b64_tr_b16 v[86:87], v105 offset:51200
v_mfma_f32_16x16x32_bf16 v[8:11], v[56:59], a[108:111], v[8:11]
ds_read_b64_tr_b16 v[88:89], v106 offset:49152
ds_read_b64_tr_b16 v[90:91], v106 offset:51200
v_mfma_f32_16x16x32_bf16 v[12:15], v[60:63], a[108:111], v[12:15]
ds_read_b64_tr_b16 v[92:93], v107 offset:49152
ds_read_b64_tr_b16 v[94:95], v107 offset:51200
v_mfma_f32_16x16x32_bf16 v[16:19], v[48:51], a[112:115], v[16:19]
v_add_u32 v104, 4294914304, v104
v_add_u32 v105, 4294914304, v105
v_mfma_f32_16x16x32_bf16 v[20:23], v[52:55], a[112:115], v[20:23]
v_add_u32 v106, 4294914304, v106
v_add_u32 v107, 4294914304, v107
v_mfma_f32_16x16x32_bf16 v[24:27], v[56:59], a[112:115], v[24:27]
s_add_u32 s69, s76, 221184
buffer_load_dwordx4 a[72:75], v245, s[24:27], s69 offen sc1
v_mfma_f32_16x16x32_bf16 v[28:31], v[60:63], a[112:115], v[28:31]
s_add_u32 s69, s77, 221184
buffer_load_dwordx4 a[76:79], v245, s[24:27], s69 offen sc1
v_mfma_f32_16x16x32_bf16 v[32:35], v[48:51], a[140:143], v[32:35]
s_add_u32 s69, s78, 221184
buffer_load_dwordx4 a[80:83], v245, s[24:27], s69 offen sc1
v_mfma_f32_16x16x32_bf16 v[36:39], v[52:55], a[140:143], v[36:39]
s_add_u32 s69, s79, 221184
buffer_load_dwordx4 a[84:87], v245, s[24:27], s69 offen sc1
v_mfma_f32_16x16x32_bf16 v[40:43], v[56:59], a[140:143], v[40:43]
s_add_u32 s69, s80, 221184
buffer_load_dwordx4 a[88:91], v245, s[24:27], s69 offen sc1
v_mfma_f32_16x16x32_bf16 v[44:47], v[60:63], a[140:143], v[44:47]
s_waitcnt lgkmcnt(8)
v_mfma_f32_16x16x32_bf16 v[0:3], v[64:67], a[116:119], v[0:3]
ds_read_b64_tr_b16 v[48:49], v108 offset:49152
ds_read_b64_tr_b16 v[50:51], v108 offset:51200
v_mfma_f32_16x16x32_bf16 v[4:7], v[68:71], a[116:119], v[4:7]
ds_read_b64_tr_b16 v[52:53], v109 offset:49152
ds_read_b64_tr_b16 v[54:55], v109 offset:51200
v_mfma_f32_16x16x32_bf16 v[8:11], v[72:75], a[116:119], v[8:11]
ds_read_b64_tr_b16 v[56:57], v110 offset:49152
ds_read_b64_tr_b16 v[58:59], v110 offset:51200
v_mfma_f32_16x16x32_bf16 v[12:15], v[76:79], a[116:119], v[12:15]
ds_read_b64_tr_b16 v[60:61], v111 offset:49152
ds_read_b64_tr_b16 v[62:63], v111 offset:51200
v_mfma_f32_16x16x32_bf16 v[16:19], v[64:67], a[120:123], v[16:19]
v_add_u32 v108, 4294914304, v108
v_add_u32 v109, 4294914304, v109
v_mfma_f32_16x16x32_bf16 v[20:23], v[68:71], a[120:123], v[20:23]
v_add_u32 v110, 4294914304, v110
v_add_u32 v111, 4294914304, v111
v_mfma_f32_16x16x32_bf16 v[24:27], v[72:75], a[120:123], v[24:27]
s_add_u32 s69, s81, 221184
buffer_load_dwordx4 a[92:95], v245, s[24:27], s69 offen sc1
v_mfma_f32_16x16x32_bf16 v[28:31], v[76:79], a[120:123], v[28:31]
s_add_u32 s69, s82, 221184
buffer_load_dwordx4 a[96:99], v245, s[24:27], s69 offen sc1
s_waitcnt lgkmcnt(8)
v_mfma_f32_16x16x32_bf16 v[0:3], v[80:83], a[124:127], v[0:3]
ds_read_b64_tr_b16 v[64:65], v96 offset:0
ds_read_b64_tr_b16 v[66:67], v96 offset:2048
v_mfma_f32_16x16x32_bf16 v[4:7], v[84:87], a[124:127], v[4:7]
ds_read_b64_tr_b16 v[68:69], v97 offset:0
ds_read_b64_tr_b16 v[70:71], v97 offset:2048
v_mfma_f32_16x16x32_bf16 v[8:11], v[88:91], a[124:127], v[8:11]
ds_read_b64_tr_b16 v[72:73], v98 offset:0
ds_read_b64_tr_b16 v[74:75], v98 offset:2048
v_mfma_f32_16x16x32_bf16 v[12:15], v[92:95], a[124:127], v[12:15]
ds_read_b64_tr_b16 v[76:77], v99 offset:0
ds_read_b64_tr_b16 v[78:79], v99 offset:2048
v_mfma_f32_16x16x32_bf16 v[16:19], v[80:83], a[128:131], v[16:19]
v_mfma_f32_16x16x32_bf16 v[20:23], v[84:87], a[128:131], v[20:23]
v_mfma_f32_16x16x32_bf16 v[24:27], v[88:91], a[128:131], v[24:27]
s_add_u32 s69, s83, 221184
buffer_load_dwordx4 a[100:103], v245, s[24:27], s69 offen sc1
v_mfma_f32_16x16x32_bf16 v[28:31], v[92:95], a[128:131], v[28:31]
s_add_u32 s69, s84, 221184
buffer_load_dwordx4 a[104:107], v245, s[24:27], s69 offen sc1
s_waitcnt lgkmcnt(8)
v_mfma_f32_16x16x32_bf16 v[0:3], v[48:51], a[132:135], v[0:3]
ds_read_b64_tr_b16 v[80:81], v100 offset:0
ds_read_b64_tr_b16 v[82:83], v100 offset:2048
v_mfma_f32_16x16x32_bf16 v[4:7], v[52:55], a[132:135], v[4:7]
ds_read_b64_tr_b16 v[84:85], v101 offset:0
ds_read_b64_tr_b16 v[86:87], v101 offset:2048
v_mfma_f32_16x16x32_bf16 v[8:11], v[56:59], a[132:135], v[8:11]
ds_read_b64_tr_b16 v[88:89], v102 offset:0
ds_read_b64_tr_b16 v[90:91], v102 offset:2048
v_mfma_f32_16x16x32_bf16 v[12:15], v[60:63], a[132:135], v[12:15]
ds_read_b64_tr_b16 v[92:93], v103 offset:0
ds_read_b64_tr_b16 v[94:95], v103 offset:2048
v_mfma_f32_16x16x32_bf16 v[16:19], v[48:51], a[136:139], v[16:19]
v_mfma_f32_16x16x32_bf16 v[20:23], v[52:55], a[136:139], v[20:23]
v_mfma_f32_16x16x32_bf16 v[24:27], v[56:59], a[136:139], v[24:27]
v_mfma_f32_16x16x32_bf16 v[28:31], v[60:63], a[136:139], v[28:31]
s_bitcmp1_b32 s94, 28
s_cbranch_scc1 L_sel7
s_waitcnt vmcnt(0)
s_cmp_lg_u32 s95, 0
s_cbranch_scc1 L_sentp7
s_lshl_b32 s69, s50, 2
s_add_u32 s69, s69, s3
s_lshl_b32 s69, s69, 3
v_mov_b32 v238, s75
v_not_b32 v239, v238
v_mov_b32 v240, 0
s_mov_b64 s[96:97], exec
s_mov_b64 exec, 1
buffer_store_dwordx2 v[238:239], v240, s[44:47], s69 offen sc1
s_mov_b64 exec, s[96:97]
s_mov_b32 s95, 1
L_sentp7:
s_mov_b32 s71, 0x100000
L_poll7:
buffer_load_dwordx2 v[112:113], v246, s[44:47], 0 offen sc1
s_not_b32 s70, s75
s_waitcnt vmcnt(0)
v_cmp_eq_u32 vcc, s75, v112
v_cmp_eq_u32 s[96:97], s70, v113
s_nop 3
s_and_b32 s94, vcc_lo, s96
s_lshr_b32 s70, s94, 1
s_lshr_b32 s69, s94, 2
s_and_b32 s94, s94, s70
s_and_b32 s94, s94, s69
s_sub_u32 s71, s71, 1
s_cmp_eq_u32 s71, 0
s_cbranch_scc1 L_sel7
s_bitcmp1_b32 s94, 28
s_cbranch_scc0 L_poll7
L_sel7:
s_waitcnt vmcnt(18)
s_waitcnt lgkmcnt(8)
v_mfma_f32_16x16x32_bf16 v[0:3], v[64:67], a[0:3], v[0:3]
ds_read_b64_tr_b16 v[48:49], v104 offset:0
ds_read_b64_tr_b16 v[50:51], v104 offset:2048
v_mfma_f32_16x16x32_bf16 v[4:7], v[68:71], a[0:3], v[4:7]
ds_read_b64_tr_b16 v[52:53], v105 offset:0
ds_read_b64_tr_b16 v[54:55], v105 offset:2048
v_mfma_f32_16x16x32_bf16 v[8:11], v[72:75], a[0:3], v[8:11]
ds_read_b64_tr_b16 v[56:57], v106 offset:0
ds_read_b64_tr_b16 v[58:59], v106 offset:2048
v_mfma_f32_16x16x32_bf16 v[12:15], v[76:79], a[0:3], v[12:15]
ds_read_b64_tr_b16 v[60:61], v107 offset:0
ds_read_b64_tr_b16 v[62:63], v107 offset:2048
v_mfma_f32_16x16x32_bf16 v[16:19], v[64:67], a[4:7], v[16:19]
v_mfma_f32_16x16x32_bf16 v[20:23], v[68:71], a[4:7], v[20:23]
v_mfma_f32_16x16x32_bf16 v[24:27], v[72:75], a[4:7], v[24:27]
s_add_u32 s69, s76, 258048
buffer_load_dwordx4 a[108:111], v245, s[24:27], s69 offen sc1
v_mfma_f32_16x16x32_bf16 v[28:31], v[76:79], a[4:7], v[28:31]
s_add_u32 s69, s77, 258048
buffer_load_dwordx4 a[112:115], v245, s[24:27], s69 offen sc1
v_mfma_f32_16x16x32_bf16 v[32:35], v[64:67], a[32:35], v[32:35]
s_add_u32 s69, s78, 258048
buffer_load_dwordx4 a[116:119], v245, s[24:27], s69 offen sc1
v_mfma_f32_16x16x32_bf16 v[36:39], v[68:71], a[32:35], v[36:39]
s_add_u32 s69, s79, 258048
buffer_load_dwordx4 a[120:123], v245, s[24:27], s69 offen sc1
v_mfma_f32_16x16x32_bf16 v[40:43], v[72:75], a[32:35], v[40:43]
s_add_u32 s69, s80, 258048
buffer_load_dwordx4 a[124:127], v245, s[24:27], s69 offen sc1
v_mfma_f32_16x16x32_bf16 v[44:47], v[76:79], a[32:35], v[44:47]
s_waitcnt lgkmcnt(8)
v_mfma_f32_16x16x32_bf16 v[0:3], v[80:83], a[8:11], v[0:3]
ds_read_b64_tr_b16 v[64:65], v108 offset:0
ds_read_b64_tr_b16 v[66:67], v108 offset:2048
v_mfma_f32_16x16x32_bf16 v[4:7], v[84:87], a[8:11], v[4:7]
ds_read_b64_tr_b16 v[68:69], v109 offset:0
ds_read_b64_tr_b16 v[70:71], v109 offset:2048
v_mfma_f32_16x16x32_bf16 v[8:11], v[88:91], a[8:11], v[8:11]
ds_read_b64_tr_b16 v[72:73], v110 offset:0
ds_read_b64_tr_b16 v[74:75], v110 offset:2048
v_mfma_f32_16x16x32_bf16 v[12:15], v[92:95], a[8:11], v[12:15]
ds_read_b64_tr_b16 v[76:77], v111 offset:0
ds_read_b64_tr_b16 v[78:79], v111 offset:2048
v_mfma_f32_16x16x32_bf16 v[16:19], v[80:83], a[12:15], v[16:19]
v_mfma_f32_16x16x32_bf16 v[20:23], v[84:87], a[12:15], v[20:23]
v_mfma_f32_16x16x32_bf16 v[24:27], v[88:91], a[12:15], v[24:27]
s_add_u32 s69, s81, 258048
buffer_load_dwordx4 a[128:131], v245, s[24:27], s69 offen sc1
v_mfma_f32_16x16x32_bf16 v[28:31], v[92:95], a[12:15], v[28:31]
s_add_u32 s69, s82, 258048
buffer_load_dwordx4 a[132:135], v245, s[24:27], s69 offen sc1
s_waitcnt lgkmcnt(8)
v_mfma_f32_16x16x32_bf16 v[0:3], v[48:51], a[16:19], v[0:3]
ds_read_b64_tr_b16 v[80:81], v96 offset:17664
ds_read_b64_tr_b16 v[82:83], v96 offset:19712
v_mfma_f32_16x16x32_bf16 v[4:7], v[52:55], a[16:19], v[4:7]
ds_read_b64_tr_b16 v[84:85], v97 offset:17664
ds_read_b64_tr_b16 v[86:87], v97 offset:19712
v_mfma_f32_16x16x32_bf16 v[8:11], v[56:59], a[16:19], v[8:11]
ds_read_b64_tr_b16 v[88:89], v98 offset:17664
ds_read_b64_tr_b16 v[90:91], v98 offset:19712
v_mfma_f32_16x16x32_bf16 v[12:15], v[60:63], a[16:19], v[12:15]
ds_read_b64_tr_b16 v[92:93], v99 offset:17664
ds_read_b64_tr_b16 v[94:95], v99 offset:19712
v_mfma_f32_16x16x32_bf16 v[16:19], v[48:51], a[20:23], v[16:19]
v_mfma_f32_16x16x32_bf16 v[20:23], v[52:55], a[20:23], v[20:23]
v_mfma_f32_16x16x32_bf16 v[24:27], v[56:59], a[20:23], v[24:27]
s_add_u32 s69, s83, 258048
buffer_load_dwordx4 a[136:139], v245, s[24:27], s69 offen sc1
v_mfma_f32_16x16x32_bf16 v[28:31], v[60:63], a[20:23], v[28:31]
s_add_u32 s69, s84, 258048
buffer_load_dwordx4 a[140:143], v245, s[24:27], s69 offen sc1
s_waitcnt lgkmcnt(8)
v_mfma_f32_16x16x32_bf16 v[0:3], v[64:67], a[24:27], v[0:3]
ds_read_b64_tr_b16 v[48:49], v100 offset:17664
ds_read_b64_tr_b16 v[50:51], v100 offset:19712
v_mfma_f32_16x16x32_bf16 v[4:7], v[68:71], a[24:27], v[4:7]
ds_read_b64_tr_b16 v[52:53], v101 offset:17664
ds_read_b64_tr_b16 v[54:55], v101 offset:19712
v_mfma_f32_16x16x32_bf16 v[8:11], v[72:75], a[24:27], v[8:11]
ds_read_b64_tr_b16 v[56:57], v102 offset:17664
ds_read_b64_tr_b16 v[58:59], v102 offset:19712
v_mfma_f32_16x16x32_bf16 v[12:15], v[76:79], a[24:27], v[12:15]
ds_read_b64_tr_b16 v[60:61], v103 offset:17664
ds_read_b64_tr_b16 v[62:63], v103 offset:19712
v_mfma_f32_16x16x32_bf16 v[16:19], v[64:67], a[28:31], v[16:19]
v_mfma_f32_16x16x32_bf16 v[20:23], v[68:71], a[28:31], v[20:23]
v_mfma_f32_16x16x32_bf16 v[24:27], v[72:75], a[28:31], v[24:27]
v_mfma_f32_16x16x32_bf16 v[28:31], v[76:79], a[28:31], v[28:31]
s_waitcnt vmcnt(18)
s_waitcnt lgkmcnt(8)
v_mfma_f32_16x16x32_bf16 v[0:3], v[80:83], a[36:39], v[0:3]
ds_read_b64_tr_b16 v[64:65], v104 offset:17664
ds_read_b64_tr_b16 v[66:67], v104 offset:19712
v_mfma_f32_16x16x32_bf16 v[4:7], v[84:87], a[36:39], v[4:7]
ds_read_b64_tr_b16 v[68:69], v105 offset:17664
ds_read_b64_tr_b16 v[70:71], v105 offset:19712
v_mfma_f32_16x16x32_bf16 v[8:11], v[88:91], a[36:39], v[8:11]
ds_read_b64_tr_b16 v[72:73], v106 offset:17664
ds_read_b64_tr_b16 v[74:75], v106 offset:19712
v_mfma_f32_16x16x32_bf16 v[12:15], v[92:95], a[36:39], v[12:15]
ds_read_b64_tr_b16 v[76:77], v107 offset:17664
ds_read_b64_tr_b16 v[78:79], v107 offset:19712
v_mfma_f32_16x16x32_bf16 v[16:19], v[80:83], a[40:43], v[16:19]
v_mfma_f32_16x16x32_bf16 v[20:23], v[84:87], a[40:43], v[20:23]
v_mfma_f32_16x16x32_bf16 v[24:27], v[88:91], a[40:43], v[24:27]
v_mfma_f32_16x16x32_bf16 v[28:31], v[92:95], a[40:43], v[28:31]
v_mfma_f32_16x16x32_bf16 v[32:35], v[80:83], a[68:71], v[32:35]
v_mfma_f32_16x16x32_bf16 v[36:39], v[84:87], a[68:71], v[36:39]
v_mfma_f32_16x16x32_bf16 v[40:43], v[88:91], a[68:71], v[40:43]
v_mfma_f32_16x16x32_bf16 v[44:47], v[92:95], a[68:71], v[44:47]
s_waitcnt lgkmcnt(8)
v_mfma_f32_16x16x32_bf16 v[0:3], v[48:51], a[44:47], v[0:3]
ds_read_b64_tr_b16 v[80:81], v108 offset:17664
ds_read_b64_tr_b16 v[82:83], v108 offset:19712
v_mfma_f32_16x16x32_bf16 v[4:7], v[52:55], a[44:47], v[4:7]
ds_read_b64_tr_b16 v[84:85], v109 offset:17664
ds_read_b64_tr_b16 v[86:87], v109 offset:19712
v_mfma_f32_16x16x32_bf16 v[8:11], v[56:59], a[44:47], v[8:11]
ds_read_b64_tr_b16 v[88:89], v110 offset:17664
ds_read_b64_tr_b16 v[90:91], v110 offset:19712
v_mfma_f32_16x16x32_bf16 v[12:15], v[60:63], a[44:47], v[12:15]
ds_read_b64_tr_b16 v[92:93], v111 offset:17664
ds_read_b64_tr_b16 v[94:95], v111 offset:19712
v_mfma_f32_16x16x32_bf16 v[16:19], v[48:51], a[48:51], v[16:19]
v_mfma_f32_16x16x32_bf16 v[20:23], v[52:55], a[48:51], v[20:23]
v_mfma_f32_16x16x32_bf16 v[24:27], v[56:59], a[48:51], v[24:27]
v_mfma_f32_16x16x32_bf16 v[28:31], v[60:63], a[48:51], v[28:31]
s_waitcnt lgkmcnt(8)
v_mfma_f32_16x16x32_bf16 v[0:3], v[64:67], a[52:55], v[0:3]
ds_read_b64_tr_b16 v[48:49], v96 offset:35328
ds_read_b64_tr_b16 v[50:51], v96 offset:37376
v_mfma_f32_16x16x32_bf16 v[4:7], v[68:71], a[52:55], v[4:7]
ds_read_b64_tr_b16 v[52:53], v97 offset:35328
ds_read_b64_tr_b16 v[54:55], v97 offset:37376
v_mfma_f32_16x16x32_bf16 v[8:11], v[72:75], a[52:55], v[8:11]
ds_read_b64_tr_b16 v[56:57], v98 offset:35328
ds_read_b64_tr_b16 v[58:59], v98 offset:37376
v_mfma_f32_16x16x32_bf16 v[12:15], v[76:79], a[52:55], v[12:15]
ds_read_b64_tr_b16 v[60:61], v99 offset:35328
ds_read_b64_tr_b16 v[62:63], v99 offset:37376
v_mfma_f32_16x16x32_bf16 v[16:19], v[64:67], a[56:59], v[16:19]
v_add_u32 v96, 4294931968, v96
v_add_u32 v97, 4294931968, v97
v_mfma_f32_16x16x32_bf16 v[20:23], v[68:71], a[56:59], v[20:23]
v_add_u32 v98, 4294931968, v98
v_add_u32 v99, 4294931968, v99
v_mfma_f32_16x16x32_bf16 v[24:27], v[72:75], a[56:59], v[24:27]
v_mfma_f32_16x16x32_bf16 v[28:31], v[76:79], a[56:59], v[28:31]
s_waitcnt lgkmcnt(8)
v_mfma_f32_16x16x32_bf16 v[0:3], v[80:83], a[60:63], v[0:3]
ds_read_b64_tr_b16 v[64:65], v100 offset:35328
ds_read_b64_tr_b16 v[66:67], v100 offset:37376
v_mfma_f32_16x16x32_bf16 v[4:7], v[84:87], a[60:63], v[4:7]
ds_read_b64_tr_b16 v[68:69], v101 offset:35328
ds_read_b64_tr_b16 v[70:71], v101 offset:37376
v_mfma_f32_16x16x32_bf16 v[8:11], v[88:91], a[60:63], v[8:11]
ds_read_b64_tr_b16 v[72:73], v102 offset:35328
ds_read_b64_tr_b16 v[74:75], v102 offset:37376
v_mfma_f32_16x16x32_bf16 v[12:15], v[92:95], a[60:63], v[12:15]
ds_read_b64_tr_b16 v[76:77], v103 offset:35328
ds_read_b64_tr_b16 v[78:79], v103 offset:37376
v_mfma_f32_16x16x32_bf16 v[16:19], v[80:83], a[64:67], v[16:19]
v_add_u32 v100, 4294931968, v100
v_add_u32 v101, 4294931968, v101
v_mfma_f32_16x16x32_bf16 v[20:23], v[84:87], a[64:67], v[20:23]
v_add_u32 v102, 4294931968, v102
v_add_u32 v103, 4294931968, v103
v_mfma_f32_16x16x32_bf16 v[24:27], v[88:91], a[64:67], v[24:27]
v_mfma_f32_16x16x32_bf16 v[28:31], v[92:95], a[64:67], v[28:31]
s_waitcnt vmcnt(9)
s_waitcnt lgkmcnt(8)
v_mfma_f32_16x16x32_bf16 v[0:3], v[48:51], a[72:75], v[0:3]
ds_read_b64_tr_b16 v[80:81], v104 offset:35328
ds_read_b64_tr_b16 v[82:83], v104 offset:37376
v_mfma_f32_16x16x32_bf16 v[4:7], v[52:55], a[72:75], v[4:7]
ds_read_b64_tr_b16 v[84:85], v105 offset:35328
ds_read_b64_tr_b16 v[86:87], v105 offset:37376
v_mfma_f32_16x16x32_bf16 v[8:11], v[56:59], a[72:75], v[8:11]
ds_read_b64_tr_b16 v[88:89], v106 offset:35328
ds_read_b64_tr_b16 v[90:91], v106 offset:37376
v_mfma_f32_16x16x32_bf16 v[12:15], v[60:63], a[72:75], v[12:15]
ds_read_b64_tr_b16 v[92:93], v107 offset:35328
ds_read_b64_tr_b16 v[94:95], v107 offset:37376
v_mfma_f32_16x16x32_bf16 v[16:19], v[48:51], a[76:79], v[16:19]
v_add_u32 v104, 4294931968, v104
v_add_u32 v105, 4294931968, v105
v_mfma_f32_16x16x32_bf16 v[20:23], v[52:55], a[76:79], v[20:23]
v_add_u32 v106, 4294931968, v106
v_add_u32 v107, 4294931968, v107
v_mfma_f32_16x16x32_bf16 v[24:27], v[56:59], a[76:79], v[24:27]
v_mfma_f32_16x16x32_bf16 v[28:31], v[60:63], a[76:79], v[28:31]
v_mfma_f32_16x16x32_bf16 v[32:35], v[48:51], a[104:107], v[32:35]
v_mfma_f32_16x16x32_bf16 v[36:39], v[52:55], a[104:107], v[36:39]
v_mfma_f32_16x16x32_bf16 v[40:43], v[56:59], a[104:107], v[40:43]
v_mfma_f32_16x16x32_bf16 v[44:47], v[60:63], a[104:107], v[44:47]
s_waitcnt lgkmcnt(8)
v_mfma_f32_16x16x32_bf16 v[0:3], v[64:67], a[80:83], v[0:3]
ds_read_b64_tr_b16 v[48:49], v108 offset:35328
ds_read_b64_tr_b16 v[50:51], v108 offset:37376
v_mfma_f32_16x16x32_bf16 v[4:7], v[68:71], a[80:83], v[4:7]
ds_read_b64_tr_b16 v[52:53], v109 offset:35328
ds_read_b64_tr_b16 v[54:55], v109 offset:37376
v_mfma_f32_16x16x32_bf16 v[8:11], v[72:75], a[80:83], v[8:11]
ds_read_b64_tr_b16 v[56:57], v110 offset:35328
ds_read_b64_tr_b16 v[58:59], v110 offset:37376
v_mfma_f32_16x16x32_bf16 v[12:15], v[76:79], a[80:83], v[12:15]
ds_read_b64_tr_b16 v[60:61], v111 offset:35328
ds_read_b64_tr_b16 v[62:63], v111 offset:37376
v_mfma_f32_16x16x32_bf16 v[16:19], v[64:67], a[84:87], v[16:19]
v_add_u32 v108, 4294931968, v108
v_add_u32 v109, 4294931968, v109
v_mfma_f32_16x16x32_bf16 v[20:23], v[68:71], a[84:87], v[20:23]
v_add_u32 v110, 4294931968, v110
v_add_u32 v111, 4294931968, v111
v_mfma_f32_16x16x32_bf16 v[24:27], v[72:75], a[84:87], v[24:27]
v_mfma_f32_16x16x32_bf16 v[28:31], v[76:79], a[84:87], v[28:31]
s_waitcnt lgkmcnt(8)
v_mfma_f32_16x16x32_bf16 v[0:3], v[80:83], a[88:91], v[0:3]
ds_read_b64_tr_b16 v[64:65], v96 offset:0
ds_read_b64_tr_b16 v[66:67], v96 offset:2048
v_mfma_f32_16x16x32_bf16 v[4:7], v[84:87], a[88:91], v[4:7]
ds_read_b64_tr_b16 v[68:69], v97 offset:0
ds_read_b64_tr_b16 v[70:71], v97 offset:2048
v_mfma_f32_16x16x32_bf16 v[8:11], v[88:91], a[88:91], v[8:11]
ds_read_b64_tr_b16 v[72:73], v98 offset:0
ds_read_b64_tr_b16 v[74:75], v98 offset:2048
v_mfma_f32_16x16x32_bf16 v[12:15], v[92:95], a[88:91], v[12:15]
ds_read_b64_tr_b16 v[76:77], v99 offset:0
ds_read_b64_tr_b16 v[78:79], v99 offset:2048
v_mfma_f32_16x16x32_bf16 v[16:19], v[80:83], a[92:95], v[16:19]
v_mfma_f32_16x16x32_bf16 v[20:23], v[84:87], a[92:95], v[20:23]
v_mfma_f32_16x16x32_bf16 v[24:27], v[88:91], a[92:95], v[24:27]
v_mfma_f32_16x16x32_bf16 v[28:31], v[92:95], a[92:95], v[28:31]
s_waitcnt lgkmcnt(8)
v_mfma_f32_16x16x32_bf16 v[0:3], v[48:51], a[96:99], v[0:3]
ds_read_b64_tr_b16 v[80:81], v100 offset:0
ds_read_b64_tr_b16 v[82:83], v100 offset:2048
v_mfma_f32_16x16x32_bf16 v[4:7], v[52:55], a[96:99], v[4:7]
ds_read_b64_tr_b16 v[84:85], v101 offset:0
ds_read_b64_tr_b16 v[86:87], v101 offset:2048
v_mfma_f32_16x16x32_bf16 v[8:11], v[56:59], a[96:99], v[8:11]
ds_read_b64_tr_b16 v[88:89], v102 offset:0
ds_read_b64_tr_b16 v[90:91], v102 offset:2048
v_mfma_f32_16x16x32_bf16 v[12:15], v[60:63], a[96:99], v[12:15]
ds_read_b64_tr_b16 v[92:93], v103 offset:0
ds_read_b64_tr_b16 v[94:95], v103 offset:2048
v_mfma_f32_16x16x32_bf16 v[16:19], v[48:51], a[100:103], v[16:19]
v_mfma_f32_16x16x32_bf16 v[20:23], v[52:55], a[100:103], v[20:23]
v_mfma_f32_16x16x32_bf16 v[24:27], v[56:59], a[100:103], v[24:27]
v_mfma_f32_16x16x32_bf16 v[28:31], v[60:63], a[100:103], v[28:31]
s_waitcnt vmcnt(0)
s_waitcnt lgkmcnt(8)
v_mfma_f32_16x16x32_bf16 v[0:3], v[64:67], a[108:111], v[0:3]
ds_read_b64_tr_b16 v[48:49], v104 offset:0
ds_read_b64_tr_b16 v[50:51], v104 offset:2048
v_mfma_f32_16x16x32_bf16 v[4:7], v[68:71], a[108:111], v[4:7]
ds_read_b64_tr_b16 v[52:53], v105 offset:0
ds_read_b64_tr_b16 v[54:55], v105 offset:2048
v_mfma_f32_16x16x32_bf16 v[8:11], v[72:75], a[108:111], v[8:11]
ds_read_b64_tr_b16 v[56:57], v106 offset:0
ds_read_b64_tr_b16 v[58:59], v106 offset:2048
v_mfma_f32_16x16x32_bf16 v[12:15], v[76:79], a[108:111], v[12:15]
ds_read_b64_tr_b16 v[60:61], v107 offset:0
ds_read_b64_tr_b16 v[62:63], v107 offset:2048
v_mfma_f32_16x16x32_bf16 v[16:19], v[64:67], a[112:115], v[16:19]
v_mfma_f32_16x16x32_bf16 v[20:23], v[68:71], a[112:115], v[20:23]
v_mfma_f32_16x16x32_bf16 v[24:27], v[72:75], a[112:115], v[24:27]
v_mfma_f32_16x16x32_bf16 v[28:31], v[76:79], a[112:115], v[28:31]
v_mfma_f32_16x16x32_bf16 v[32:35], v[64:67], a[140:143], v[32:35]
v_mfma_f32_16x16x32_bf16 v[36:39], v[68:71], a[140:143], v[36:39]
v_mfma_f32_16x16x32_bf16 v[40:43], v[72:75], a[140:143], v[40:43]
v_mfma_f32_16x16x32_bf16 v[44:47], v[76:79], a[140:143], v[44:47]
s_waitcnt lgkmcnt(8)
v_mfma_f32_16x16x32_bf16 v[0:3], v[80:83], a[116:119], v[0:3]
ds_read_b64_tr_b16 v[64:65], v108 offset:0
ds_read_b64_tr_b16 v[66:67], v108 offset:2048
v_mfma_f32_16x16x32_bf16 v[4:7], v[84:87], a[116:119], v[4:7]
ds_read_b64_tr_b16 v[68:69], v109 offset:0
ds_read_b64_tr_b16 v[70:71], v109 offset:2048
v_mfma_f32_16x16x32_bf16 v[8:11], v[88:91], a[116:119], v[8:11]
ds_read_b64_tr_b16 v[72:73], v110 offset:0
ds_read_b64_tr_b16 v[74:75], v110 offset:2048
v_mfma_f32_16x16x32_bf16 v[12:15], v[92:95], a[116:119], v[12:15]
ds_read_b64_tr_b16 v[76:77], v111 offset:0
ds_read_b64_tr_b16 v[78:79], v111 offset:2048
v_mfma_f32_16x16x32_bf16 v[16:19], v[80:83], a[120:123], v[16:19]
v_mfma_f32_16x16x32_bf16 v[20:23], v[84:87], a[120:123], v[20:23]
v_mfma_f32_16x16x32_bf16 v[24:27], v[88:91], a[120:123], v[24:27]
v_mfma_f32_16x16x32_bf16 v[28:31], v[92:95], a[120:123], v[28:31]
s_lshl_b32 s69, s3, 12
s_add_u32 s69, s69, 17664
v_add_u32 v238, s69, v245
ds_write_b128 v238, v[32:35] offset:0
ds_write_b128 v238, v[36:39] offset:1024
ds_write_b128 v238, v[40:43] offset:2048
ds_write_b128 v238, v[44:47] offset:3072
s_waitcnt lgkmcnt(8)
v_mfma_f32_16x16x32_bf16 v[0:3], v[48:51], a[124:127], v[0:3]
v_mfma_f32_16x16x32_bf16 v[4:7], v[52:55], a[124:127], v[4:7]
v_mfma_f32_16x16x32_bf16 v[8:11], v[56:59], a[124:127], v[8:11]
v_mfma_f32_16x16x32_bf16 v[12:15], v[60:63], a[124:127], v[12:15]
v_mfma_f32_16x16x32_bf16 v[16:19], v[48:51], a[128:131], v[16:19]
v_mfma_f32_16x16x32_bf16 v[20:23], v[52:55], a[128:131], v[20:23]
v_mfma_f32_16x16x32_bf16 v[24:27], v[56:59], a[128:131], v[24:27]
v_mfma_f32_16x16x32_bf16 v[28:31], v[60:63], a[128:131], v[28:31]
s_waitcnt lgkmcnt(0)
s_barrier
s_lshl_b32 s69, s3, 10
s_add_u32 s69, s69, 17664
v_add_u32 v238, s69, v245
ds_read_b128 v[116:119], v238 offset:0
ds_read_b128 v[120:123], v238 offset:4096
ds_read_b128 v[124:127], v238 offset:8192
ds_read_b128 v[128:131], v238 offset:12288
v_mfma_f32_16x16x32_bf16 v[0:3], v[64:67], a[132:135], v[0:3]
v_mfma_f32_16x16x32_bf16 v[4:7], v[68:71], a[132:135], v[4:7]
v_mfma_f32_16x16x32_bf16 v[8:11], v[72:75], a[132:135], v[8:11]
v_mfma_f32_16x16x32_bf16 v[12:15], v[76:79], a[132:135], v[12:15]
v_mfma_f32_16x16x32_bf16 v[16:19], v[64:67], a[136:139], v[16:19]
v_mfma_f32_16x16x32_bf16 v[20:23], v[68:71], a[136:139], v[20:23]
v_mfma_f32_16x16x32_bf16 v[24:27], v[72:75], a[136:139], v[24:27]
v_mfma_f32_16x16x32_bf16 v[28:31], v[76:79], a[136:139], v[28:31]
s_add_u32 s44, s18, 16908288
s_addc_u32 s45, s19, 0
s_mov_b32 s46, 8192
s_mov_b32 s47, 0x20000
s_waitcnt lgkmcnt(0)
v_add_f32 v116, v116, v120
v_add_f32 v124, v124, v128
v_add_f32 v117, v117, v121
v_add_f32 v125, v125, v129
v_add_f32 v118, v118, v122
v_add_f32 v126, v126, v130
v_add_f32 v119, v119, v123
v_add_f32 v127, v127, v131
v_add_f32 v32, v116, v124
v_add_f32 v33, v117, v125
v_add_f32 v34, v118, v126
v_add_f32 v35, v119, v127
s_cmp_eq_u32 s3, s73
s_cbranch_scc1 L_final
s_mul_i32 s70, s73, 9216
s_add_u32 s69, s70, 8192
buffer_store_dwordx4 v[32:35], v245, s[20:23], s69 offen sc1
s_add_u32 s69, s70, 0
buffer_store_dwordx4 v[0:3], v245, s[20:23], s69 offen sc1
s_add_u32 s69, s70, 1024
buffer_store_dwordx4 v[4:7], v245, s[20:23], s69 offen sc1
s_add_u32 s69, s70, 2048
buffer_store_dwordx4 v[8:11], v245, s[20:23], s69 offen sc1
s_add_u32 s69, s70, 3072
buffer_store_dwordx4 v[12:15], v245, s[20:23], s69 offen sc1
s_add_u32 s69, s70, 4096
buffer_store_dwordx4 v[16:19], v245, s[20:23], s69 offen sc1
s_add_u32 s69, s70, 5120
buffer_store_dwordx4 v[20:23], v245, s[20:23], s69 offen sc1
s_add_u32 s69, s70, 6144
buffer_store_dwordx4 v[24:27], v245, s[20:23], s69 offen sc1
s_add_u32 s69, s70, 7168
buffer_store_dwordx4 v[28:31], v245, s[20:23], s69 offen sc1
s_lshl_b32 s69, s89, 2
s_add_u32 s69, s69, s73
s_lshl_b32 s69, s69, 3
v_mov_b32 v238, s75
v_not_b32 v239, v238
v_mov_b32 v240, 0
s_waitcnt vmcnt(0)
s_mov_b64 exec, 1
buffer_store_dwordx2 v[238:239], v240, s[44:47], s69 offen sc1
s_branch L_fin
L_final:
v_and_b32 v241, 3, v236
v_lshlrev_b32 v241, 3, v241
s_lshl_b32 s69, s89, 5
v_add_u32 v241, s69, v241
s_lshl_b32 s93, 1, s73
s_xor_b32 s93, s93, 15
s_mov_b32 s71, 0x100000
L_fpoll:
buffer_load_dwordx2 v[112:113], v241, s[44:47], 0 offen sc1
s_not_b32 s70, s75
s_waitcnt vmcnt(0)
v_cmp_eq_u32 vcc, s75, v112
v_cmp_eq_u32 s[96:97], s70, v113
s_nop 3
s_and_b32 s69, vcc_lo, s96
s_and_b32 s69, s69, s93
s_sub_u32 s71, s71, 1
s_cmp_eq_u32 s71, 0
s_cbranch_scc1 L_fgo
s_cmp_eq_u32 s69, s93
s_cbranch_scc0 L_fpoll
L_fgo:
s_add_u32 s70, s73, 1
s_and_b32 s70, s70, 3
s_mul_i32 s70, s70, 9216
s_add_u32 s69, s70, 0
buffer_load_dwordx4 v[116:119], v245, s[20:23], s69 offen sc1
s_add_u32 s69, s70, 1024
buffer_load_dwordx4 v[120:123], v245, s[20:23], s69 offen sc1
s_add_u32 s69, s70, 2048
buffer_load_dwordx4 v[124:127], v245, s[20:23], s69 offen sc1
s_add_u32 s69, s70, 3072
buffer_load_dwordx4 v[128:131], v245, s[20:23], s69 offen sc1
s_add_u32 s69, s70, 4096
buffer_load_dwordx4 v[132:135], v245, s[20:23], s69 offen sc1
s_add_u32 s69, s70, 5120
buffer_load_dwordx4 v[136:139], v245, s[20:23], s69 offen sc1
s_add_u32 s69, s70, 6144
buffer_load_dwordx4 v[140:143], v245, s[20:23], s69 offen sc1
s_add_u32 s69, s70, 7168
buffer_load_dwordx4 v[144:147], v245, s[20:23], s69 offen sc1
s_add_u32 s69, s70, 8192
buffer_load_dwordx4 v[148:151], v245, s[20:23], s69 offen sc1
s_add_u32 s70, s73, 2
s_and_b32 s70, s70, 3
s_mul_i32 s70, s70, 9216
s_add_u32 s69, s70, 0
buffer_load_dwordx4 v[152:155], v245, s[20:23], s69 offen sc1
s_add_u32 s69, s70, 1024
buffer_load_dwordx4 v[156:159], v245, s[20:23], s69 offen sc1
s_add_u32 s69, s70, 2048
buffer_load_dwordx4 v[160:163], v245, s[20:23], s69 offen sc1
s_add_u32 s69, s70, 3072
buffer_load_dwordx4 v[164:167], v245, s[20:23], s69 offen sc1
s_add_u32 s69, s70, 4096
buffer_load_dwordx4 v[168:171], v245, s[20:23], s69 offen sc1
s_add_u32 s69, s70, 5120
buffer_load_dwordx4 v[172:175], v245, s[20:23], s69 offen sc1
s_add_u32 s69, s70, 6144
buffer_load_dwordx4 v[176:179], v245, s[20:23], s69 offen sc1
s_add_u32 s69, s70, 7168
buffer_load_dwordx4 v[180:183], v245, s[20:23], s69 offen sc1
s_add_u32 s69, s70, 8192
buffer_load_dwordx4 v[184:187], v245, s[20:23], s69 offen sc1
s_add_u32 s70, s73, 3
s_and_b32 s70, s70, 3
s_mul_i32 s70, s70, 9216
s_add_u32 s69, s70, 0
buffer_load_dwordx4 v[188:191], v245, s[20:23], s69 offen sc1
s_add_u32 s69, s70, 1024
buffer_load_dwordx4 v[192:195], v245, s[20:23], s69 offen sc1
s_add_u32 s69, s70, 2048
buffer_load_dwordx4 v[196:199], v245, s[20:23], s69 offen sc1
s_add_u32 s69, s70, 3072
buffer_load_dwordx4 v[200:203], v245, s[20:23], s69 offen sc1
s_add_u32 s69, s70, 4096
buffer_load_dwordx4 v[204:207], v245, s[20:23], s69 offen sc1
s_add_u32 s69, s70, 5120
buffer_load_dwordx4 v[208:211], v245, s[20:23], s69 offen sc1
s_add_u32 s69, s70, 6144
buffer_load_dwordx4 v[212:215], v245, s[20:23], s69 offen sc1
s_add_u32 s69, s70, 7168
buffer_load_dwordx4 v[216:219], v245, s[20:23], s69 offen sc1
s_add_u32 s69, s70, 8192
buffer_load_dwordx4 v[220:223], v245, s[20:23], s69 offen sc1
v_and_b32 v238, 15, v236
v_lshlrev_b32 v238, 10, v238
v_lshrrev_b32 v239, 4, v236
v_lshlrev_b32 v239, 3, v239
v_add_u32 v238, v238, v239
s_mul_i32 s69, s72, 147456
s_lshl_b32 s70, s74, 7
s_add_u32 s100, s69, s70
s_mov_b32 s24, s14
s_mov_b32 s25, s15
s_mov_b32 s26, 1179648
s_mov_b32 s27, 0x20000
s_waitcnt vmcnt(0)
v_add_f32 v0, v0, v116
v_add_f32 v152, v152, v188
v_add_f32 v1, v1, v117
v_add_f32 v153, v153, v189
v_add_f32 v2, v2, v118
v_add_f32 v154, v154, v190
v_add_f32 v3, v3, v119
v_add_f32 v155, v155, v191
v_add_f32 v0, v0, v152
v_add_f32 v1, v1, v153
v_add_f32 v2, v2, v154
v_add_f32 v3, v3, v155
v_cvt_pk_bf16_f32 v48, v0, v1
v_cvt_pk_bf16_f32 v49, v2, v3
s_lshl_b32 s69, s3, 15
s_add_u32 s69, s69, 0
s_add_u32 s69, s69, s100
buffer_store_dwordx2 v[48:49], v238, s[24:27], s69 offen
v_add_f32 v4, v4, v120
v_add_f32 v156, v156, v192
v_add_f32 v5, v5, v121
v_add_f32 v157, v157, v193
v_add_f32 v6, v6, v122
v_add_f32 v158, v158, v194
v_add_f32 v7, v7, v123
v_add_f32 v159, v159, v195
v_add_f32 v4, v4, v156
v_add_f32 v5, v5, v157
v_add_f32 v6, v6, v158
v_add_f32 v7, v7, v159
v_cvt_pk_bf16_f32 v50, v4, v5
v_cvt_pk_bf16_f32 v51, v6, v7
s_lshl_b32 s69, s3, 15
s_add_u32 s69, s69, 32
s_add_u32 s69, s69, s100
buffer_store_dwordx2 v[50:51], v238, s[24:27], s69 offen
v_add_f32 v8, v8, v124
v_add_f32 v160, v160, v196
v_add_f32 v9, v9, v125
v_add_f32 v161, v161, v197
v_add_f32 v10, v10, v126
v_add_f32 v162, v162, v198
v_add_f32 v11, v11, v127
v_add_f32 v163, v163, v199
v_add_f32 v8, v8, v160
v_add_f32 v9, v9, v161
v_add_f32 v10, v10, v162
v_add_f32 v11, v11, v163
v_cvt_pk_bf16_f32 v52, v8, v9
v_cvt_pk_bf16_f32 v53, v10, v11
s_lshl_b32 s69, s3, 15
s_add_u32 s69, s69, 64
s_add_u32 s69, s69, s100
buffer_store_dwordx2 v[52:53], v238, s[24:27], s69 offen
v_add_f32 v12, v12, v128
v_add_f32 v164, v164, v200
v_add_f32 v13, v13, v129
v_add_f32 v165, v165, v201
v_add_f32 v14, v14, v130
v_add_f32 v166, v166, v202
v_add_f32 v15, v15, v131
v_add_f32 v167, v167, v203
v_add_f32 v12, v12, v164
v_add_f32 v13, v13, v165
v_add_f32 v14, v14, v166
v_add_f32 v15, v15, v167
v_cvt_pk_bf16_f32 v54, v12, v13
v_cvt_pk_bf16_f32 v55, v14, v15
s_lshl_b32 s69, s3, 15
s_add_u32 s69, s69, 96
s_add_u32 s69, s69, s100
buffer_store_dwordx2 v[54:55], v238, s[24:27], s69 offen
v_add_f32 v16, v16, v132
v_add_f32 v168, v168, v204
v_add_f32 v17, v17, v133
v_add_f32 v169, v169, v205
v_add_f32 v18, v18, v134
v_add_f32 v170, v170, v206
v_add_f32 v19, v19, v135
v_add_f32 v171, v171, v207
v_add_f32 v16, v16, v168
v_add_f32 v17, v17, v169
v_add_f32 v18, v18, v170
v_add_f32 v19, v19, v171
v_cvt_pk_bf16_f32 v56, v16, v17
v_cvt_pk_bf16_f32 v57, v18, v19
s_lshl_b32 s69, s3, 15
s_add_u32 s69, s69, 16384
s_add_u32 s69, s69, s100
buffer_store_dwordx2 v[56:57], v238, s[24:27], s69 offen
v_add_f32 v20, v20, v136
v_add_f32 v172, v172, v208
v_add_f32 v21, v21, v137
v_add_f32 v173, v173, v209
v_add_f32 v22, v22, v138
v_add_f32 v174, v174, v210
v_add_f32 v23, v23, v139
v_add_f32 v175, v175, v211
v_add_f32 v20, v20, v172
v_add_f32 v21, v21, v173
v_add_f32 v22, v22, v174
v_add_f32 v23, v23, v175
v_cvt_pk_bf16_f32 v58, v20, v21
v_cvt_pk_bf16_f32 v59, v22, v23
s_lshl_b32 s69, s3, 15
s_add_u32 s69, s69, 16416
s_add_u32 s69, s69, s100
buffer_store_dwordx2 v[58:59], v238, s[24:27], s69 offen
v_add_f32 v24, v24, v140
v_add_f32 v176, v176, v212
v_add_f32 v25, v25, v141
v_add_f32 v177, v177, v213
v_add_f32 v26, v26, v142
v_add_f32 v178, v178, v214
v_add_f32 v27, v27, v143
v_add_f32 v179, v179, v215
v_add_f32 v24, v24, v176
v_add_f32 v25, v25, v177
v_add_f32 v26, v26, v178
v_add_f32 v27, v27, v179
v_cvt_pk_bf16_f32 v60, v24, v25
v_cvt_pk_bf16_f32 v61, v26, v27
s_lshl_b32 s69, s3, 15
s_add_u32 s69, s69, 16448
s_add_u32 s69, s69, s100
buffer_store_dwordx2 v[60:61], v238, s[24:27], s69 offen
v_add_f32 v28, v28, v144
v_add_f32 v180, v180, v216
v_add_f32 v29, v29, v145
v_add_f32 v181, v181, v217
v_add_f32 v30, v30, v146
v_add_f32 v182, v182, v218
v_add_f32 v31, v31, v147
v_add_f32 v183, v183, v219
v_add_f32 v28, v28, v180
v_add_f32 v29, v29, v181
v_add_f32 v30, v30, v182
v_add_f32 v31, v31, v183
v_cvt_pk_bf16_f32 v62, v28, v29
v_cvt_pk_bf16_f32 v63, v30, v31
s_lshl_b32 s69, s3, 15
s_add_u32 s69, s69, 16480
s_add_u32 s69, s69, s100
buffer_store_dwordx2 v[62:63], v238, s[24:27], s69 offen
v_add_f32 v32, v32, v148
v_add_f32 v184, v184, v220
v_add_f32 v33, v33, v149
v_add_f32 v185, v185, v221
v_add_f32 v34, v34, v150
v_add_f32 v186, v186, v222
v_add_f32 v35, v35, v151
v_add_f32 v187, v187, v223
v_add_f32 v32, v32, v184
v_add_f32 v33, v33, v185
v_add_f32 v34, v34, v186
v_add_f32 v35, v35, v187
v_cvt_pk_bf16_f32 v64, v32, v33
v_cvt_pk_bf16_f32 v65, v34, v35
s_lshl_b32 s69, s3, 5
s_add_u32 s69, s69, 131072
s_add_u32 s69, s69, s100
buffer_store_dwordx2 v[64:65], v238, s[24:27], s69 offen
s_branch L_fin
L_fallback:
s_cmp_lg_u32 s95, 2
s_cbranch_scc1 L_fb_done
s_mul_i32 s58, s3, 4352
s_add_u32 s58, s58, 17664
v_add_u32 v232, s58, v234
v_add_u32 v233, s58, v235
v_subrev_u32 v233, 8448, v233
v_mov_b32 v204, 0xff800000
v_mov_b32 v208, 0xff800000
v_mov_b32 v212, 0xff800000
s_mov_b32 s56, 0
s_mov_b32 s54, 64
L_fb1:
s_add_u32 m0, s58, 0
s_add_u32 s69, s56, 0
buffer_load_dwordx4 v237, s[28:31], s69 offen lds
s_add_u32 m0, s58, 1056
s_add_u32 s69, s56, 1024
buffer_load_dwordx4 v237, s[28:31], s69 offen lds
s_add_u32 m0, s58, 2112
s_add_u32 s69, s56, 2048
buffer_load_dwordx4 v237, s[28:31], s69 offen lds
s_add_u32 m0, s58, 3168
s_add_u32 s69, s56, 3072
buffer_load_dwordx4 v237, s[28:31], s69 offen lds
s_waitcnt vmcnt(0)
ds_read_b128 a[0:3], v232 offset:0
ds_read_b128 a[4:7], v232 offset:256
ds_read_b128 a[8:11], v232 offset:512
ds_read_b128 a[12:15], v232 offset:768
s_waitcnt lgkmcnt(0)
s_add_u32 m0, s58, 0
s_add_u32 s69, s56, 4096
buffer_load_dwordx4 v237, s[28:31], s69 offen lds
s_add_u32 m0, s58, 1056
s_add_u32 s69, s56, 5120
buffer_load_dwordx4 v237, s[28:31], s69 offen lds
s_add_u32 m0, s58, 2112
s_add_u32 s69, s56, 6144
buffer_load_dwordx4 v237, s[28:31], s69 offen lds
s_add_u32 m0, s58, 3168
s_add_u32 s69, s56, 7168
buffer_load_dwordx4 v237, s[28:31], s69 offen lds
s_waitcnt vmcnt(0)
ds_read_b128 a[16:19], v232 offset:0
ds_read_b128 a[20:23], v232 offset:256
ds_read_b128 a[24:27], v232 offset:512
ds_read_b128 a[28:31], v232 offset:768
s_waitcnt lgkmcnt(0)
v_mfma_f32_16x16x32_bf16 v[144:147], a[0:3], v[96:99], 0
v_mfma_f32_16x16x32_bf16 v[144:147], a[4:7], v[100:103], v[144:147]
v_mfma_f32_16x16x32_bf16 v[144:147], a[8:11], v[104:107], v[144:147]
v_mfma_f32_16x16x32_bf16 v[144:147], a[12:15], v[108:111], v[144:147]
v_mfma_f32_16x16x32_bf16 v[148:151], a[16:19], v[96:99], 0
v_mfma_f32_16x16x32_bf16 v[148:151], a[20:23], v[100:103], v[148:151]
v_mfma_f32_16x16x32_bf16 v[148:151], a[24:27], v[104:107], v[148:151]
v_mfma_f32_16x16x32_bf16 v[148:151], a[28:31], v[108:111], v[148:151]
v_mfma_f32_16x16x32_bf16 v[152:155], a[0:3], v[112:115], 0
v_mfma_f32_16x16x32_bf16 v[152:155], a[4:7], v[116:119], v[152:155]
v_mfma_f32_16x16x32_bf16 v[152:155], a[8:11], v[120:123], v[152:155]
v_mfma_f32_16x16x32_bf16 v[152:155], a[12:15], v[124:127], v[152:155]
v_mfma_f32_16x16x32_bf16 v[156:159], a[16:19], v[112:115], 0
v_mfma_f32_16x16x32_bf16 v[156:159], a[20:23], v[116:119], v[156:159]
v_mfma_f32_16x16x32_bf16 v[156:159], a[24:27], v[120:123], v[156:159]
v_mfma_f32_16x16x32_bf16 v[156:159], a[28:31], v[124:127], v[156:159]
v_mfma_f32_16x16x32_bf16 v[160:163], a[0:3], v[128:131], 0
v_mfma_f32_16x16x32_bf16 v[160:163], a[4:7], v[132:135], v[160:163]
v_mfma_f32_16x16x32_bf16 v[160:163], a[8:11], v[136:139], v[160:163]
v_mfma_f32_16x16x32_bf16 v[160:163], a[12:15], v[140:143], v[160:163]
v_mfma_f32_16x16x32_bf16 v[164:167], a[16:19], v[128:131], 0
v_mfma_f32_16x16x32_bf16 v[164:167], a[20:23], v[132:135], v[164:167]
v_mfma_f32_16x16x32_bf16 v[164:167], a[24:27], v[136:139], v[164:167]
v_mfma_f32_16x16x32_bf16 v[164:167], a[28:31], v[140:143], v[164:167]
s_nop 7
v_max3_f32 v204, v204, v144, v145
v_max3_f32 v204, v204, v146, v147
v_max3_f32 v204, v204, v148, v149
v_max3_f32 v204, v204, v150, v151
v_max3_f32 v208, v208, v152, v153
v_max3_f32 v208, v208, v154, v155
v_max3_f32 v208, v208, v156, v157
v_max3_f32 v208, v208, v158, v159
v_max3_f32 v212, v212, v160, v161
v_max3_f32 v212, v212, v162, v163
v_max3_f32 v212, v212, v164, v165
v_max3_f32 v212, v212, v166, v167
s_add_u32 s56, s56, 8192
s_sub_u32 s54, s54, 1
s_cmp_lg_u32 s54, 0
s_cbranch_scc1 L_fb1
v_xor_b32 v238, 16, v236
v_lshlrev_b32 v238, 2, v238
v_xor_b32 v239, 32, v236
v_lshlrev_b32 v239, 2, v239
ds_bpermute_b32 v242, v238, v204
ds_bpermute_b32 v243, v238, v208
ds_bpermute_b32 v244, v238, v212
s_waitcnt lgkmcnt(0)
v_max_f32 v204, v204, v242
v_max_f32 v208, v208, v243
v_max_f32 v212, v212, v244
ds_bpermute_b32 v242, v239, v204
ds_bpermute_b32 v243, v239, v208
ds_bpermute_b32 v244, v239, v212
s_waitcnt lgkmcnt(0)
v_max_f32 v204, v204, v242
v_max_f32 v208, v208, v243
v_max_f32 v212, v212, v244
v_sub_f32 v204, 0, v204
v_mov_b32 v205, v204
v_mov_b32 v206, v204
v_mov_b32 v207, v204
v_sub_f32 v208, 0, v208
v_mov_b32 v209, v208
v_mov_b32 v210, v208
v_mov_b32 v211, v208
v_sub_f32 v212, 0, v212
v_mov_b32 v213, v212
v_mov_b32 v214, v212
v_mov_b32 v215, v212
v_mov_b32 v0, 0
v_mov_b32 v1, 0
v_mov_b32 v2, 0
v_mov_b32 v3, 0
v_mov_b32 v4, 0
v_mov_b32 v5, 0
v_mov_b32 v6, 0
v_mov_b32 v7, 0
v_mov_b32 v8, 0
v_mov_b32 v9, 0
v_mov_b32 v10, 0
v_mov_b32 v11, 0
v_mov_b32 v12, 0
v_mov_b32 v13, 0
v_mov_b32 v14, 0
v_mov_b32 v15, 0
v_mov_b32 v16, 0
v_mov_b32 v17, 0
v_mov_b32 v18, 0
v_mov_b32 v19, 0
v_mov_b32 v20, 0
v_mov_b32 v21, 0
v_mov_b32 v22, 0
v_mov_b32 v23, 0
v_mov_b32 v24, 0
v_mov_b32 v25, 0
v_mov_b32 v26, 0
v_mov_b32 v27, 0
v_mov_b32 v28, 0
v_mov_b32 v29, 0
v_mov_b32 v30, 0
v_mov_b32 v31, 0
v_mov_b32 v32, 0
v_mov_b32 v33, 0
v_mov_b32 v34, 0
v_mov_b32 v35, 0
v_mov_b32 v36, 0
v_mov_b32 v37, 0
v_mov_b32 v38, 0
v_mov_b32 v39, 0
v_mov_b32 v40, 0
v_mov_b32 v41, 0
v_mov_b32 v42, 0
v_mov_b32 v43, 0
v_mov_b32 v44, 0
v_mov_b32 v45, 0
v_mov_b32 v46, 0
v_mov_b32 v47, 0
v_mov_b32 v48, 0
v_mov_b32 v49, 0
v_mov_b32 v50, 0
v_mov_b32 v51, 0
v_mov_b32 v52, 0
v_mov_b32 v53, 0
v_mov_b32 v54, 0
v_mov_b32 v55, 0
v_mov_b32 v56, 0
v_mov_b32 v57, 0
v_mov_b32 v58, 0
v_mov_b32 v59, 0
v_mov_b32 v60, 0
v_mov_b32 v61, 0
v_mov_b32 v62, 0
v_mov_b32 v63, 0
v_mov_b32 v64, 0
v_mov_b32 v65, 0
v_mov_b32 v66, 0
v_mov_b32 v67, 0
v_mov_b32 v68, 0
v_mov_b32 v69, 0
v_mov_b32 v70, 0
v_mov_b32 v71, 0
v_mov_b32 v72, 0
v_mov_b32 v73, 0
v_mov_b32 v74, 0
v_mov_b32 v75, 0
v_mov_b32 v76, 0
v_mov_b32 v77, 0
v_mov_b32 v78, 0
v_mov_b32 v79, 0
v_mov_b32 v80, 0
v_mov_b32 v81, 0
v_mov_b32 v82, 0
v_mov_b32 v83, 0
v_mov_b32 v84, 0
v_mov_b32 v85, 0
v_mov_b32 v86, 0
v_mov_b32 v87, 0
v_mov_b32 v88, 0
v_mov_b32 v89, 0
v_mov_b32 v90, 0
v_mov_b32 v91, 0
v_mov_b32 v92, 0
v_mov_b32 v93, 0
v_mov_b32 v94, 0
v_mov_b32 v95, 0
v_mov_b32 v216, 0
v_mov_b32 v217, 0
v_mov_b32 v218, 0
v_mov_b32 v219, 0
v_mov_b32 v220, 0
v_mov_b32 v221, 0
v_mov_b32 v222, 0
v_mov_b32 v223, 0
v_mov_b32 v224, 0
v_mov_b32 v225, 0
v_mov_b32 v226, 0
v_mov_b32 v227, 0
v_mov_b32 v228, 0x3f803f80
v_mov_b32 v229, 0x3f803f80
v_mov_b32 v230, 0x3f803f80
v_mov_b32 v231, 0x3f803f80
s_mov_b32 s56, 0
s_mov_b32 s54, 64
L_fb2:
s_add_u32 m0, s58, 0
s_add_u32 s69, s56, 0
buffer_load_dwordx4 v237, s[28:31], s69 offen lds
s_add_u32 m0, s58, 1056
s_add_u32 s69, s56, 1024
buffer_load_dwordx4 v237, s[28:31], s69 offen lds
s_add_u32 m0, s58, 2112
s_add_u32 s69, s56, 2048
buffer_load_dwordx4 v237, s[28:31], s69 offen lds
s_add_u32 m0, s58, 3168
s_add_u32 s69, s56, 3072
buffer_load_dwordx4 v237, s[28:31], s69 offen lds
s_waitcnt vmcnt(0)
ds_read_b128 a[0:3], v232 offset:0
ds_read_b128 a[4:7], v232 offset:256
ds_read_b128 a[8:11], v232 offset:512
ds_read_b128 a[12:15], v232 offset:768
s_waitcnt lgkmcnt(0)
s_add_u32 m0, s58, 0
s_add_u32 s69, s56, 4096
buffer_load_dwordx4 v237, s[28:31], s69 offen lds
s_add_u32 m0, s58, 1056
s_add_u32 s69, s56, 5120
buffer_load_dwordx4 v237, s[28:31], s69 offen lds
s_add_u32 m0, s58, 2112
s_add_u32 s69, s56, 6144
buffer_load_dwordx4 v237, s[28:31], s69 offen lds
s_add_u32 m0, s58, 3168
s_add_u32 s69, s56, 7168
buffer_load_dwordx4 v237, s[28:31], s69 offen lds
s_waitcnt vmcnt(0)
ds_read_b128 a[16:19], v232 offset:0
ds_read_b128 a[20:23], v232 offset:256
ds_read_b128 a[24:27], v232 offset:512
ds_read_b128 a[28:31], v232 offset:768
s_waitcnt lgkmcnt(0)
s_add_u32 m0, s58, 0
s_add_u32 s69, s56, 0
buffer_load_dwordx4 v237, s[32:35], s69 offen lds
s_add_u32 m0, s58, 1056
s_add_u32 s69, s56, 1024
buffer_load_dwordx4 v237, s[32:35], s69 offen lds
s_add_u32 m0, s58, 2112
s_add_u32 s69, s56, 2048
buffer_load_dwordx4 v237, s[32:35], s69 offen lds
s_add_u32 m0, s58, 3168
s_add_u32 s69, s56, 3072
buffer_load_dwordx4 v237, s[32:35], s69 offen lds
s_waitcnt vmcnt(0)
ds_read_b64_tr_b16 a[32:33], v233 offset:0
ds_read_b64_tr_b16 a[36:37], v233 offset:32
ds_read_b64_tr_b16 a[40:41], v233 offset:256
ds_read_b64_tr_b16 a[44:45], v233 offset:288
ds_read_b64_tr_b16 a[48:49], v233 offset:512
ds_read_b64_tr_b16 a[52:53], v233 offset:544
ds_read_b64_tr_b16 a[56:57], v233 offset:768
ds_read_b64_tr_b16 a[60:61], v233 offset:800
s_waitcnt lgkmcnt(0)
s_add_u32 m0, s58, 0
s_add_u32 s69, s56, 4096
buffer_load_dwordx4 v237, s[32:35], s69 offen lds
s_add_u32 m0, s58, 1056
s_add_u32 s69, s56, 5120
buffer_load_dwordx4 v237, s[32:35], s69 offen lds
s_add_u32 m0, s58, 2112
s_add_u32 s69, s56, 6144
buffer_load_dwordx4 v237, s[32:35], s69 offen lds
s_add_u32 m0, s58, 3168
s_add_u32 s69, s56, 7168
buffer_load_dwordx4 v237, s[32:35], s69 offen lds
s_waitcnt vmcnt(0)
ds_read_b64_tr_b16 a[34:35], v233 offset:0
ds_read_b64_tr_b16 a[38:39], v233 offset:32
ds_read_b64_tr_b16 a[42:43], v233 offset:256
ds_read_b64_tr_b16 a[46:47], v233 offset:288
ds_read_b64_tr_b16 a[50:51], v233 offset:512
ds_read_b64_tr_b16 a[54:55], v233 offset:544
ds_read_b64_tr_b16 a[58:59], v233 offset:768
ds_read_b64_tr_b16 a[62:63], v233 offset:800
s_waitcnt lgkmcnt(0)
v_mfma_f32_16x16x32_bf16 v[144:147], a[0:3], v[96:99], v[204:207]
v_mfma_f32_16x16x32_bf16 v[144:147], a[4:7], v[100:103], v[144:147]
v_mfma_f32_16x16x32_bf16 v[144:147], a[8:11], v[104:107], v[144:147]
v_mfma_f32_16x16x32_bf16 v[144:147], a[12:15], v[108:111], v[144:147]
v_mfma_f32_16x16x32_bf16 v[148:151], a[16:19], v[96:99], v[204:207]
v_mfma_f32_16x16x32_bf16 v[148:151], a[20:23], v[100:103], v[148:151]
v_mfma_f32_16x16x32_bf16 v[148:151], a[24:27], v[104:107], v[148:151]
v_mfma_f32_16x16x32_bf16 v[148:151], a[28:31], v[108:111], v[148:151]
v_mfma_f32_16x16x32_bf16 v[152:155], a[0:3], v[112:115], v[208:211]
v_mfma_f32_16x16x32_bf16 v[152:155], a[4:7], v[116:119], v[152:155]
v_mfma_f32_16x16x32_bf16 v[152:155], a[8:11], v[120:123], v[152:155]
v_mfma_f32_16x16x32_bf16 v[152:155], a[12:15], v[124:127], v[152:155]
v_mfma_f32_16x16x32_bf16 v[156:159], a[16:19], v[112:115], v[208:211]
v_mfma_f32_16x16x32_bf16 v[156:159], a[20:23], v[116:119], v[156:159]
v_mfma_f32_16x16x32_bf16 v[156:159], a[24:27], v[120:123], v[156:159]
v_mfma_f32_16x16x32_bf16 v[156:159], a[28:31], v[124:127], v[156:159]
v_mfma_f32_16x16x32_bf16 v[160:163], a[0:3], v[128:131], v[212:215]
v_mfma_f32_16x16x32_bf16 v[160:163], a[4:7], v[132:135], v[160:163]
v_mfma_f32_16x16x32_bf16 v[160:163], a[8:11], v[136:139], v[160:163]
v_mfma_f32_16x16x32_bf16 v[160:163], a[12:15], v[140:143], v[160:163]
v_mfma_f32_16x16x32_bf16 v[164:167], a[16:19], v[128:131], v[212:215]
v_mfma_f32_16x16x32_bf16 v[164:167], a[20:23], v[132:135], v[164:167]
v_mfma_f32_16x16x32_bf16 v[164:167], a[24:27], v[136:139], v[164:167]
v_mfma_f32_16x16x32_bf16 v[164:167], a[28:31], v[140:143], v[164:167]
s_nop 7
v_exp_f32 v144, v144
v_exp_f32 v145, v145
v_exp_f32 v146, v146
v_exp_f32 v147, v147
v_exp_f32 v148, v148
v_exp_f32 v149, v149
v_exp_f32 v150, v150
v_exp_f32 v151, v151
v_exp_f32 v152, v152
v_exp_f32 v153, v153
v_exp_f32 v154, v154
v_exp_f32 v155, v155
v_exp_f32 v156, v156
v_exp_f32 v157, v157
v_exp_f32 v158, v158
v_exp_f32 v159, v159
v_exp_f32 v160, v160
v_exp_f32 v161, v161
v_exp_f32 v162, v162
v_exp_f32 v163, v163
v_exp_f32 v164, v164
v_exp_f32 v165, v165
v_exp_f32 v166, v166
v_exp_f32 v167, v167
s_nop 0
v_cvt_pk_bf16_f32 v192, v144, v145
v_cvt_pk_bf16_f32 v193, v146, v147
v_cvt_pk_bf16_f32 v194, v148, v149
v_cvt_pk_bf16_f32 v195, v150, v151
v_cvt_pk_bf16_f32 v196, v152, v153
v_cvt_pk_bf16_f32 v197, v154, v155
v_cvt_pk_bf16_f32 v198, v156, v157
v_cvt_pk_bf16_f32 v199, v158, v159
v_cvt_pk_bf16_f32 v200, v160, v161
v_cvt_pk_bf16_f32 v201, v162, v163
v_cvt_pk_bf16_f32 v202, v164, v165
v_cvt_pk_bf16_f32 v203, v166, v167
s_nop 1
v_mfma_f32_16x16x32_bf16 v[0:3], a[32:35], v[192:195], v[0:3]
v_mfma_f32_16x16x32_bf16 v[32:35], a[32:35], v[196:199], v[32:35]
v_mfma_f32_16x16x32_bf16 v[64:67], a[32:35], v[200:203], v[64:67]
v_mfma_f32_16x16x32_bf16 v[4:7], a[36:39], v[192:195], v[4:7]
v_mfma_f32_16x16x32_bf16 v[36:39], a[36:39], v[196:199], v[36:39]
v_mfma_f32_16x16x32_bf16 v[68:71], a[36:39], v[200:203], v[68:71]
v_mfma_f32_16x16x32_bf16 v[8:11], a[40:43], v[192:195], v[8:11]
v_mfma_f32_16x16x32_bf16 v[40:43], a[40:43], v[196:199], v[40:43]
v_mfma_f32_16x16x32_bf16 v[72:75], a[40:43], v[200:203], v[72:75]
v_mfma_f32_16x16x32_bf16 v[12:15], a[44:47], v[192:195], v[12:15]
v_mfma_f32_16x16x32_bf16 v[44:47], a[44:47], v[196:199], v[44:47]
v_mfma_f32_16x16x32_bf16 v[76:79], a[44:47], v[200:203], v[76:79]
v_mfma_f32_16x16x32_bf16 v[16:19], a[48:51], v[192:195], v[16:19]
v_mfma_f32_16x16x32_bf16 v[48:51], a[48:51], v[196:199], v[48:51]
v_mfma_f32_16x16x32_bf16 v[80:83], a[48:51], v[200:203], v[80:83]
v_mfma_f32_16x16x32_bf16 v[20:23], a[52:55], v[192:195], v[20:23]
v_mfma_f32_16x16x32_bf16 v[52:55], a[52:55], v[196:199], v[52:55]
v_mfma_f32_16x16x32_bf16 v[84:87], a[52:55], v[200:203], v[84:87]
v_mfma_f32_16x16x32_bf16 v[24:27], a[56:59], v[192:195], v[24:27]
v_mfma_f32_16x16x32_bf16 v[56:59], a[56:59], v[196:199], v[56:59]
v_mfma_f32_16x16x32_bf16 v[88:91], a[56:59], v[200:203], v[88:91]
v_mfma_f32_16x16x32_bf16 v[28:31], a[60:63], v[192:195], v[28:31]
v_mfma_f32_16x16x32_bf16 v[60:63], a[60:63], v[196:199], v[60:63]
v_mfma_f32_16x16x32_bf16 v[92:95], a[60:63], v[200:203], v[92:95]
v_mfma_f32_16x16x32_bf16 v[216:219], v[228:231], v[192:195], v[216:219]
v_mfma_f32_16x16x32_bf16 v[220:223], v[228:231], v[196:199], v[220:223]
v_mfma_f32_16x16x32_bf16 v[224:227], v[228:231], v[200:203], v[224:227]
s_add_u32 s56, s56, 8192
s_sub_u32 s54, s54, 1
s_cmp_lg_u32 s54, 0
s_cbranch_scc1 L_fb2
s_nop 7
s_mov_b32 s95, 0
v_rcp_f32 v238, v216
v_rcp_f32 v240, v220
v_rcp_f32 v242, v224
v_mov_b32 v239, v238
v_mov_b32 v241, v240
v_mov_b32 v243, v242
s_mul_i32 s69, s3, 12288
v_pk_mul_f32 v[0:1], v[0:1], v[238:239]
v_pk_mul_f32 v[2:3], v[2:3], v[238:239]
v_pk_mul_f32 v[4:5], v[4:5], v[238:239]
v_pk_mul_f32 v[6:7], v[6:7], v[238:239]
v_cvt_pk_bf16_f32 v144, v0, v1
v_cvt_pk_bf16_f32 v145, v2, v3
v_cvt_pk_bf16_f32 v146, v4, v5
v_cvt_pk_bf16_f32 v147, v6, v7
s_add_u32 s70, s69, 0
buffer_store_dwordx4 v[144:147], v245, s[36:39], s70 offen sc1
v_pk_mul_f32 v[8:9], v[8:9], v[238:239]
v_pk_mul_f32 v[10:11], v[10:11], v[238:239]
v_pk_mul_f32 v[12:13], v[12:13], v[238:239]
v_pk_mul_f32 v[14:15], v[14:15], v[238:239]
v_cvt_pk_bf16_f32 v148, v8, v9
v_cvt_pk_bf16_f32 v149, v10, v11
v_cvt_pk_bf16_f32 v150, v12, v13
v_cvt_pk_bf16_f32 v151, v14, v15
s_add_u32 s70, s69, 1024
buffer_store_dwordx4 v[148:151], v245, s[36:39], s70 offen sc1
v_pk_mul_f32 v[16:17], v[16:17], v[238:239]
v_pk_mul_f32 v[18:19], v[18:19], v[238:239]
v_pk_mul_f32 v[20:21], v[20:21], v[238:239]
v_pk_mul_f32 v[22:23], v[22:23], v[238:239]
v_cvt_pk_bf16_f32 v152, v16, v17
v_cvt_pk_bf16_f32 v153, v18, v19
v_cvt_pk_bf16_f32 v154, v20, v21
v_cvt_pk_bf16_f32 v155, v22, v23
s_add_u32 s70, s69, 2048
buffer_store_dwordx4 v[152:155], v245, s[36:39], s70 offen sc1
v_pk_mul_f32 v[24:25], v[24:25], v[238:239]
v_pk_mul_f32 v[26:27], v[26:27], v[238:239]
v_pk_mul_f32 v[28:29], v[28:29], v[238:239]
v_pk_mul_f32 v[30:31], v[30:31], v[238:239]
v_cvt_pk_bf16_f32 v156, v24, v25
v_cvt_pk_bf16_f32 v157, v26, v27
v_cvt_pk_bf16_f32 v158, v28, v29
v_cvt_pk_bf16_f32 v159, v30, v31
s_add_u32 s70, s69, 3072
buffer_store_dwordx4 v[156:159], v245, s[36:39], s70 offen sc1
v_pk_mul_f32 v[32:33], v[32:33], v[240:241]
v_pk_mul_f32 v[34:35], v[34:35], v[240:241]
v_pk_mul_f32 v[36:37], v[36:37], v[240:241]
v_pk_mul_f32 v[38:39], v[38:39], v[240:241]
v_cvt_pk_bf16_f32 v160, v32, v33
v_cvt_pk_bf16_f32 v161, v34, v35
v_cvt_pk_bf16_f32 v162, v36, v37
v_cvt_pk_bf16_f32 v163, v38, v39
s_add_u32 s70, s69, 4096
buffer_store_dwordx4 v[160:163], v245, s[36:39], s70 offen sc1
v_pk_mul_f32 v[40:41], v[40:41], v[240:241]
v_pk_mul_f32 v[42:43], v[42:43], v[240:241]
v_pk_mul_f32 v[44:45], v[44:45], v[240:241]
v_pk_mul_f32 v[46:47], v[46:47], v[240:241]
v_cvt_pk_bf16_f32 v164, v40, v41
v_cvt_pk_bf16_f32 v165, v42, v43
v_cvt_pk_bf16_f32 v166, v44, v45
v_cvt_pk_bf16_f32 v167, v46, v47
s_add_u32 s70, s69, 5120
buffer_store_dwordx4 v[164:167], v245, s[36:39], s70 offen sc1
v_pk_mul_f32 v[48:49], v[48:49], v[240:241]
v_pk_mul_f32 v[50:51], v[50:51], v[240:241]
v_pk_mul_f32 v[52:53], v[52:53], v[240:241]
v_pk_mul_f32 v[54:55], v[54:55], v[240:241]
v_cvt_pk_bf16_f32 v168, v48, v49
v_cvt_pk_bf16_f32 v169, v50, v51
v_cvt_pk_bf16_f32 v170, v52, v53
v_cvt_pk_bf16_f32 v171, v54, v55
s_add_u32 s70, s69, 6144
buffer_store_dwordx4 v[168:171], v245, s[36:39], s70 offen sc1
v_pk_mul_f32 v[56:57], v[56:57], v[240:241]
v_pk_mul_f32 v[58:59], v[58:59], v[240:241]
v_pk_mul_f32 v[60:61], v[60:61], v[240:241]
v_pk_mul_f32 v[62:63], v[62:63], v[240:241]
v_cvt_pk_bf16_f32 v172, v56, v57
v_cvt_pk_bf16_f32 v173, v58, v59
v_cvt_pk_bf16_f32 v174, v60, v61
v_cvt_pk_bf16_f32 v175, v62, v63
s_add_u32 s70, s69, 7168
buffer_store_dwordx4 v[172:175], v245, s[36:39], s70 offen sc1
v_pk_mul_f32 v[64:65], v[64:65], v[242:243]
v_pk_mul_f32 v[66:67], v[66:67], v[242:243]
v_pk_mul_f32 v[68:69], v[68:69], v[242:243]
v_pk_mul_f32 v[70:71], v[70:71], v[242:243]
v_cvt_pk_bf16_f32 v176, v64, v65
v_cvt_pk_bf16_f32 v177, v66, v67
v_cvt_pk_bf16_f32 v178, v68, v69
v_cvt_pk_bf16_f32 v179, v70, v71
s_add_u32 s70, s69, 8192
buffer_store_dwordx4 v[176:179], v245, s[36:39], s70 offen sc1
v_pk_mul_f32 v[72:73], v[72:73], v[242:243]
v_pk_mul_f32 v[74:75], v[74:75], v[242:243]
v_pk_mul_f32 v[76:77], v[76:77], v[242:243]
v_pk_mul_f32 v[78:79], v[78:79], v[242:243]
v_cvt_pk_bf16_f32 v180, v72, v73
v_cvt_pk_bf16_f32 v181, v74, v75
v_cvt_pk_bf16_f32 v182, v76, v77
v_cvt_pk_bf16_f32 v183, v78, v79
s_add_u32 s70, s69, 9216
buffer_store_dwordx4 v[180:183], v245, s[36:39], s70 offen sc1
v_pk_mul_f32 v[80:81], v[80:81], v[242:243]
v_pk_mul_f32 v[82:83], v[82:83], v[242:243]
v_pk_mul_f32 v[84:85], v[84:85], v[242:243]
v_pk_mul_f32 v[86:87], v[86:87], v[242:243]
v_cvt_pk_bf16_f32 v184, v80, v81
v_cvt_pk_bf16_f32 v185, v82, v83
v_cvt_pk_bf16_f32 v186, v84, v85
v_cvt_pk_bf16_f32 v187, v86, v87
s_add_u32 s70, s69, 10240
buffer_store_dwordx4 v[184:187], v245, s[36:39], s70 offen sc1
v_pk_mul_f32 v[88:89], v[88:89], v[242:243]
v_pk_mul_f32 v[90:91], v[90:91], v[242:243]
v_pk_mul_f32 v[92:93], v[92:93], v[242:243]
v_pk_mul_f32 v[94:95], v[94:95], v[242:243]
v_cvt_pk_bf16_f32 v188, v88, v89
v_cvt_pk_bf16_f32 v189, v90, v91
v_cvt_pk_bf16_f32 v190, v92, v93
v_cvt_pk_bf16_f32 v191, v94, v95
s_add_u32 s70, s69, 11264
buffer_store_dwordx4 v[188:191], v245, s[36:39], s70 offen sc1
L_fb_done:
s_barrier
s_mov_b32 s54, 1
s_branch L_reinit
L_fin:
s_cmp_lg_u32 s2, 0
s_cbranch_scc1 L_nz
s_cmp_lg_u32 s3, 3
s_cbranch_scc1 L_nz
s_mov_b64 exec, 1
v_mov_b32 v2, 0
v_mov_b32 v3, 0
v_mov_b32 v4, 0
global_store_dwordx2 v4, v[2:3], s[16:17] sc1
L_nz:
L_end:
s_endpgm
L_code_end:

.section .rodata,"a"
.p2align 6
.amdhsa_kernel standalone__gqa_block_cached__near_ridge_kernel
  .amdhsa_next_free_vgpr 512
  .amdhsa_next_free_sgpr 102
  .amdhsa_accum_offset 256
  .amdhsa_group_segment_fixed_size 0
  .amdhsa_kernarg_size 64
  .amdhsa_user_sgpr_count 2
  .amdhsa_user_sgpr_kernarg_segment_ptr 1
  .amdhsa_system_sgpr_workgroup_id_x 1
.end_amdhsa_kernel
```
